```python
import torch

def _softmax(x, axis=-1):
    return torch.softmax(x, dim=axis)
def _gelu(x):
    return torch.nn.functional.gelu(x, approximate="tanh")
def _silu(x):
    return torch.nn.functional.silu(x)
def _sigmoid(x):
    return torch.sigmoid(x)
def _layernorm(x, axis=-1, eps=1e-5):
    m = x.mean(dim=axis, keepdim=True)
    v = x.var(dim=axis, keepdim=True, unbiased=False)
    return (x - m) / torch.sqrt(v + eps)
def _scatter_add(tgt, idx, src, axis=0):
    return tgt.clone().index_add_(axis, idx, src)
def _segment_sum(src, seg, n):
    out = torch.zeros((n,) + src.shape[1:], dtype=src.dtype)
    return out.index_add_(0, seg, src)
def _pad(x, pw):
    flat = tuple(v for pair in reversed(pw) for v in pair)
    return torch.nn.functional.pad(x, flat)

kernel_name = 'gated_mix__spectral_fnet__mha_block__prompt'

def setup_inputs():

    _w = (lambda a: (lambda t: t.to(torch.bfloat16) if t.is_floating_point() else t)(torch.as_tensor(a)))
    def _A_setup():
        B, S, D = 1, 2048, 1024
        ns = torch.arange(S)[:, None] * torch.arange(S)[None, :]
        nd = torch.arange(D)[:, None] * torch.arange(D)[None, :]
        Ws_re = torch.cos(-2.0 * torch.pi * ns / S).to(float)
        Ws_im = torch.sin(-2.0 * torch.pi * ns / S).to(float)
        Wd_re = torch.cos(-2.0 * torch.pi * nd / D).to(float)
        Wd_im = torch.sin(-2.0 * torch.pi * nd / D).to(float)
        return {
            "x": _w((lambda *s: torch.randn(*s, dtype=torch.bfloat16) * 0.05)(B, S, D)),
            "dft_seq_re": _w(Ws_re),
            "dft_seq_im": _w(Ws_im),
            "dft_hid_re": _w(Wd_re),
            "dft_hid_im": _w(Wd_im),
        }
    _A_in = _A_setup()

    def _B_setup():
        B, S, D, H = 1, 2048, 1024, 32
        return {
            "x": _w((lambda *s: torch.randn(*s, dtype=torch.bfloat16) * 0.05)(B, S, D)),
            "wqkv": _w((lambda *s: torch.randn(*s, dtype=torch.bfloat16) * 1.6)(D, 3 * D)),
            "wo": _w((lambda *s: torch.randn(*s, dtype=torch.bfloat16) * 0.2)(D, D)),
        }
    _B_in = _B_setup()

    return {
        "A_x": _A_in["x"],
        "A_dft_seq_re": _A_in["dft_seq_re"],
        "A_dft_seq_im": _A_in["dft_seq_im"],
        "A_dft_hid_re": _A_in["dft_hid_re"],
        "A_dft_hid_im": _A_in["dft_hid_im"],
        "B_x": _B_in["x"],
        "B_wqkv": _B_in["wqkv"],
        "B_wo": _B_in["wo"],
        "gate_w": _w((lambda *s: torch.randn(*s, dtype=torch.bfloat16) * 0.05)(1024) * 16.0),
    }

def reference(A_x, A_dft_seq_re, A_dft_seq_im, A_dft_hid_re, A_dft_hid_im, B_x, B_wqkv, B_wo, gate_w):
    def _A_ref(x, dft_seq_re, dft_seq_im, dft_hid_re, dft_hid_im):
        a = torch.einsum("bsd,ed->bse", x, dft_hid_re)
        b = torch.einsum("bsd,ed->bse", x, dft_hid_im)
        y = torch.einsum("ts,bse->bte", dft_seq_re, a) - torch.einsum("ts,bse->bte", dft_seq_im, b)
        return y

    def _B_ref(x, wqkv, wo):
        B, S, D = x.shape
        H = 32
        Dh = D // H
        qkv = (lambda x, *d: x.permute(*d))((x @ wqkv).reshape(B, S, 3, H, Dh), 2, 0, 3, 1, 4)
        q, k, v = qkv[0], qkv[1], qkv[2]
        scores = torch.einsum("bhqd,bhkd->bhqk", q, k) * (Dh ** -0.5)
        p = _softmax(scores, axis=-1)
        o = torch.einsum("bhqk,bhkd->bhqd", p, v)
        return (lambda x, *d: x.permute(*d))(o, 0, 2, 1, 3).reshape(B, S, D) @ wo

    x = A_x
    g = _sigmoid((x * gate_w).sum(-1, keepdims=True))
    a = _A_ref(x, A_dft_seq_re, A_dft_seq_im, A_dft_hid_re, A_dft_hid_im)
    b = _B_ref(x, B_wqkv, B_wo)
    return g * a + (1 - g) * b
```

```asm
; @launch kernel=k1_kernel grid=(256,1,1) block=(512,1,1) lds=163840
; @launch kernel=k2_kernel grid=(256,1,1) block=(512,1,1) lds=163840
.amdgcn_target "amdgcn-amd-amdhsa--gfx950"
.text
.globl k1_kernel
.p2align 8
.type k1_kernel,@function
k1_kernel:
    s_cmp_ge_u32 s2, 256
    s_cbranch_scc1 K1_END
    s_load_dwordx2 s[8:9], s[0:1], 0
    s_load_dwordx2 s[12:13], s[0:1], 48
    s_load_dwordx2 s[16:17], s[0:1], 88
    s_load_dwordx2 s[20:21], s[0:1], 64
    s_load_dwordx2 s[88:89], s[0:1], 56
    v_lshrrev_b32 v1, 6, v0
    v_and_b32 v99, 63, v0
    s_mov_b32 s10, 0x400000
    v_readfirstlane_b32 s3, v1
    s_mov_b32 s11, 0x20000
    s_mov_b32 s14, 0x600000
    s_mov_b32 s15, 0x20000
    s_mov_b32 s18, 27262976
    s_mov_b32 s19, 0x20000
    s_mov_b32 s22, 0x800
    s_mov_b32 s23, 0x20000
    s_mov_b32 s90, 0x200000
    s_mov_b32 s91, 0x20000
    s_and_b32 s4, s2, 1
    s_lshl_b32 s4, s4, 3
    s_bfe_u32 s5, s2, 0x30003
    s_add_u32 s4, s4, s5
    s_bfe_u32 s5, s2, 0x20001
    s_lshl_b32 s5, s5, 2
    s_lshr_b32 s6, s2, 6
    s_add_u32 s5, s5, s6
    s_cmp_ge_u32 s3, 4
    s_cbranch_scc1 K1_PROD
    s_setprio 2
    s_and_b32 s24, s3, 1
    s_lshr_b32 s25, s3, 1
    v_and_b32 v146, 7, v99
    v_bfe_u32 v147, v99, 3, 1
    v_mad_u32_u24 v146, v147, 24, v146
    v_lshrrev_b32 v147, 4, v99
    v_bfe_u32 v148, v146, 1, 3
    v_xor_b32 v148, v148, v147
    v_lshlrev_b32 v148, 4, v148
    v_lshl_or_b32 v148, v146, 7, v148
    s_lshl_b32 s26, s24, 13
    v_add_u32 v140, s26, v148
    v_xor_b32 v141, 64, v140
    v_xor_b32 v142, 0x440, v140
    v_xor_b32 v143, 0x400, v140
    v_lshlrev_b32 v135, 9, v147
    v_lshl_or_b32 v132, v146, 4, v135
    v_xor_b32 v133, 128, v132
    v_bfe_u32 v148, v99, 2, 2
    v_lshl_or_b32 v134, v148, 7, v135
    v_and_b32 v149, 3, v99
    v_lshl_or_b32 v134, v149, 4, v134
    v_and_b32 v146, 15, v99
    v_lshl_or_b32 v135, v146, 4, v135
    v_lshl_or_b32 v148, v147, 3, v148
    v_lshlrev_b32 v148, 7, v148
    v_lshl_or_b32 v148, v149, 3, v148
    v_bfe_u32 v149, v99, 3, 1
    v_xor_b32 v149, s25, v149
    v_lshl_or_b32 v148, v149, 6, v148
    v_bfe_u32 v149, v99, 4, 1
    v_lshl_or_b32 v148, v149, 5, v148
    v_add_u32 v154, 0x10000, v148
    v_add_u32 v155, 0x1c000, v148
    v_xor_b32 v156, 32, v154
    v_xor_b32 v157, 32, v155
    v_lshlrev_b32 v146, 4, v99
    s_getpc_b64 s[36:37]
K1_PC:
    s_lshr_b32 s28, s2, 3
    s_lshl_b32 s28, s28, 2
    s_add_u32 s28, s28, s3
    s_lshl_b32 s28, s28, 9
    v_lshlrev_b32 v150, 7, v99
    v_add_u32 v150, s28, v150
    v_min_u32 v150, TEXT_END-K1_PC-4, v150
    s_mov_b64 exec, 15
    global_load_dword v151, v150, s[36:37]
    s_mov_b64 exec, -1
    v_mov_b32 v0, 0
    v_mov_b32 v1, 0
    v_mov_b32 v2, 0
    v_mov_b32 v3, 0
    v_mov_b32 v4, 0
    v_mov_b32 v5, 0
    v_mov_b32 v6, 0
    v_mov_b32 v7, 0
    v_mov_b32 v8, 0
    v_mov_b32 v9, 0
    v_mov_b32 v10, 0
    v_mov_b32 v11, 0
    v_mov_b32 v12, 0
    v_mov_b32 v13, 0
    v_mov_b32 v14, 0
    v_mov_b32 v15, 0
    v_mov_b32 v16, 0
    v_mov_b32 v17, 0
    v_mov_b32 v18, 0
    v_mov_b32 v19, 0
    v_mov_b32 v20, 0
    v_mov_b32 v21, 0
    v_mov_b32 v22, 0
    v_mov_b32 v23, 0
    v_mov_b32 v24, 0
    v_mov_b32 v25, 0
    v_mov_b32 v26, 0
    v_mov_b32 v27, 0
    v_mov_b32 v28, 0
    v_mov_b32 v29, 0
    v_mov_b32 v30, 0
    v_mov_b32 v31, 0
    v_mov_b32 v32, 0
    v_mov_b32 v33, 0
    v_mov_b32 v34, 0
    v_mov_b32 v35, 0
    v_mov_b32 v36, 0
    v_mov_b32 v37, 0
    v_mov_b32 v38, 0
    v_mov_b32 v39, 0
    v_mov_b32 v40, 0
    v_mov_b32 v41, 0
    v_mov_b32 v42, 0
    v_mov_b32 v43, 0
    v_mov_b32 v44, 0
    v_mov_b32 v45, 0
    v_mov_b32 v46, 0
    v_mov_b32 v47, 0
    v_mov_b32 v48, 0
    v_mov_b32 v49, 0
    v_mov_b32 v50, 0
    v_mov_b32 v51, 0
    v_mov_b32 v52, 0
    v_mov_b32 v53, 0
    v_mov_b32 v54, 0
    v_mov_b32 v55, 0
    v_mov_b32 v56, 0
    v_mov_b32 v57, 0
    v_mov_b32 v58, 0
    v_mov_b32 v59, 0
    v_mov_b32 v60, 0
    v_mov_b32 v61, 0
    v_mov_b32 v62, 0
    v_mov_b32 v63, 0
    v_mov_b32 v64, 0
    v_mov_b32 v65, 0
    v_mov_b32 v66, 0
    v_mov_b32 v67, 0
    v_mov_b32 v68, 0
    v_mov_b32 v69, 0
    v_mov_b32 v70, 0
    v_mov_b32 v71, 0
    v_mov_b32 v72, 0
    v_mov_b32 v73, 0
    v_mov_b32 v74, 0
    v_mov_b32 v75, 0
    v_mov_b32 v76, 0
    v_mov_b32 v77, 0
    v_mov_b32 v78, 0
    v_mov_b32 v79, 0
    v_mov_b32 v80, 0
    v_mov_b32 v81, 0
    v_mov_b32 v82, 0
    v_mov_b32 v83, 0
    v_mov_b32 v84, 0
    v_mov_b32 v85, 0
    v_mov_b32 v86, 0
    v_mov_b32 v87, 0
    v_mov_b32 v88, 0
    v_mov_b32 v89, 0
    v_mov_b32 v90, 0
    v_mov_b32 v91, 0
    v_mov_b32 v92, 0
    v_mov_b32 v93, 0
    v_mov_b32 v94, 0
    v_mov_b32 v95, 0
    s_mov_b32 s27, 4
    s_or_b32 s28, s2, s3
    s_cbranch_scc1 K1_NOZ
    s_mov_b32 s28, 15859712
    s_waitcnt lgkmcnt(0)
    buffer_store_dwordx4 v[0:3], v146, s[16:19], s28 offen
    buffer_store_dwordx4 v[0:3], v146, s[16:19], s28 offen offset:1024
K1_NOZ:
    s_barrier
    ds_read_b128 v[160:163], v140 offset:0
    ds_read_b64_tr_b16 v[192:193], v154 offset:0
    ds_read_b64_tr_b16 v[194:195], v154 offset:512
    ds_read_b128 v[164:167], v142 offset:0
    ds_read_b64_tr_b16 v[196:197], v156 offset:0
    ds_read_b64_tr_b16 v[198:199], v156 offset:512
    ds_read_b128 v[168:171], v140 offset:4096
    ds_read_b64_tr_b16 v[200:201], v154 offset:8192
    ds_read_b64_tr_b16 v[202:203], v154 offset:8704
    ds_read_b128 v[172:175], v142 offset:4096
    ds_read_b64_tr_b16 v[204:205], v156 offset:8192
    ds_read_b64_tr_b16 v[206:207], v156 offset:8704
    ds_read_b64_tr_b16 v[208:209], v154 offset:16384
    ds_read_b64_tr_b16 v[210:211], v154 offset:16896
    ds_read_b64_tr_b16 v[212:213], v156 offset:16384
    ds_read_b64_tr_b16 v[214:215], v156 offset:16896
.p2align 6
K1_CLOOP:
    s_waitcnt lgkmcnt(0)
    v_mfma_f32_16x16x32_bf16 v[0:3], v[192:195], v[160:163], v[0:3]
    ds_read_b128 v[176:179], v141 offset:0
    v_mfma_f32_16x16x32_bf16 v[8:11], v[192:195], v[164:167], v[8:11]
    ds_read_b64_tr_b16 v[216:217], v154 offset:4096
    v_mfma_f32_16x16x32_bf16 v[48:51], v[192:195], v[168:171], v[48:51]
    ds_read_b64_tr_b16 v[218:219], v154 offset:4608
    v_mfma_f32_16x16x32_bf16 v[56:59], v[192:195], v[172:175], v[56:59]
    ds_read_b128 v[180:183], v143 offset:0
    v_mfma_f32_16x16x32_bf16 v[4:7], v[196:199], v[160:163], v[4:7]
    ds_read_b64_tr_b16 v[220:221], v156 offset:4096
    v_mfma_f32_16x16x32_bf16 v[12:15], v[196:199], v[164:167], v[12:15]
    ds_read_b64_tr_b16 v[222:223], v156 offset:4608
    v_mfma_f32_16x16x32_bf16 v[52:55], v[196:199], v[168:171], v[52:55]
    ds_read_b128 v[184:187], v141 offset:4096
    v_mfma_f32_16x16x32_bf16 v[60:63], v[196:199], v[172:175], v[60:63]
    ds_read_b64_tr_b16 v[224:225], v154 offset:12288
    v_mfma_f32_16x16x32_bf16 v[16:19], v[200:203], v[160:163], v[16:19]
    ds_read_b64_tr_b16 v[226:227], v154 offset:12800
    v_mfma_f32_16x16x32_bf16 v[24:27], v[200:203], v[164:167], v[24:27]
    ds_read_b128 v[188:191], v143 offset:4096
    v_mfma_f32_16x16x32_bf16 v[64:67], v[200:203], v[168:171], v[64:67]
    ds_read_b64_tr_b16 v[228:229], v156 offset:12288
    v_mfma_f32_16x16x32_bf16 v[72:75], v[200:203], v[172:175], v[72:75]
    ds_read_b64_tr_b16 v[230:231], v156 offset:12800
    v_mfma_f32_16x16x32_bf16 v[20:23], v[204:207], v[160:163], v[20:23]
    ds_read_b64_tr_b16 v[232:233], v154 offset:20480
    v_mfma_f32_16x16x32_bf16 v[28:31], v[204:207], v[164:167], v[28:31]
    ds_read_b64_tr_b16 v[234:235], v154 offset:20992
    v_mfma_f32_16x16x32_bf16 v[68:71], v[204:207], v[168:171], v[68:71]
    ds_read_b64_tr_b16 v[236:237], v156 offset:20480
    v_mfma_f32_16x16x32_bf16 v[76:79], v[204:207], v[172:175], v[76:79]
    ds_read_b64_tr_b16 v[238:239], v156 offset:20992
    v_mfma_f32_16x16x32_bf16 v[32:35], v[160:163], v[208:211], v[32:35]
    v_mfma_f32_16x16x32_bf16 v[36:39], v[164:167], v[208:211], v[36:39]
    v_mfma_f32_16x16x32_bf16 v[80:83], v[168:171], v[208:211], v[80:83]
    v_mfma_f32_16x16x32_bf16 v[84:87], v[172:175], v[208:211], v[84:87]
    v_mfma_f32_16x16x32_bf16 v[40:43], v[160:163], v[212:215], v[40:43]
    v_mfma_f32_16x16x32_bf16 v[44:47], v[164:167], v[212:215], v[44:47]
    v_mfma_f32_16x16x32_bf16 v[88:91], v[168:171], v[212:215], v[88:91]
    v_mfma_f32_16x16x32_bf16 v[92:95], v[172:175], v[212:215], v[92:95]
    s_waitcnt lgkmcnt(0)
    v_mfma_f32_16x16x32_bf16 v[0:3], v[216:219], v[176:179], v[0:3]
    v_mfma_f32_16x16x32_bf16 v[8:11], v[216:219], v[180:183], v[8:11]
    v_mfma_f32_16x16x32_bf16 v[48:51], v[216:219], v[184:187], v[48:51]
    v_mfma_f32_16x16x32_bf16 v[56:59], v[216:219], v[188:191], v[56:59]
    s_barrier
    ds_read_b128 v[160:163], v140 offset:16384
    v_mfma_f32_16x16x32_bf16 v[4:7], v[220:223], v[176:179], v[4:7]
    ds_read_b64_tr_b16 v[192:193], v154 offset:24576
    v_mfma_f32_16x16x32_bf16 v[12:15], v[220:223], v[180:183], v[12:15]
    ds_read_b64_tr_b16 v[194:195], v154 offset:25088
    v_mfma_f32_16x16x32_bf16 v[52:55], v[220:223], v[184:187], v[52:55]
    ds_read_b128 v[164:167], v142 offset:16384
    v_mfma_f32_16x16x32_bf16 v[60:63], v[220:223], v[188:191], v[60:63]
    ds_read_b64_tr_b16 v[196:197], v156 offset:24576
    v_mfma_f32_16x16x32_bf16 v[16:19], v[224:227], v[176:179], v[16:19]
    ds_read_b64_tr_b16 v[198:199], v156 offset:25088
    v_mfma_f32_16x16x32_bf16 v[24:27], v[224:227], v[180:183], v[24:27]
    ds_read_b128 v[168:171], v140 offset:20480
    v_mfma_f32_16x16x32_bf16 v[64:67], v[224:227], v[184:187], v[64:67]
    ds_read_b64_tr_b16 v[200:201], v154 offset:32768
    v_mfma_f32_16x16x32_bf16 v[72:75], v[224:227], v[188:191], v[72:75]
    ds_read_b64_tr_b16 v[202:203], v154 offset:33280
    v_mfma_f32_16x16x32_bf16 v[20:23], v[228:231], v[176:179], v[20:23]
    ds_read_b128 v[172:175], v142 offset:20480
    v_mfma_f32_16x16x32_bf16 v[28:31], v[228:231], v[180:183], v[28:31]
    ds_read_b64_tr_b16 v[204:205], v156 offset:32768
    v_mfma_f32_16x16x32_bf16 v[68:71], v[228:231], v[184:187], v[68:71]
    ds_read_b64_tr_b16 v[206:207], v156 offset:33280
    v_mfma_f32_16x16x32_bf16 v[76:79], v[228:231], v[188:191], v[76:79]
    ds_read_b64_tr_b16 v[208:209], v154 offset:40960
    v_mfma_f32_16x16x32_bf16 v[32:35], v[176:179], v[232:235], v[32:35]
    ds_read_b64_tr_b16 v[210:211], v154 offset:41472
    v_mfma_f32_16x16x32_bf16 v[36:39], v[180:183], v[232:235], v[36:39]
    ds_read_b64_tr_b16 v[212:213], v156 offset:40960
    v_mfma_f32_16x16x32_bf16 v[80:83], v[184:187], v[232:235], v[80:83]
    ds_read_b64_tr_b16 v[214:215], v156 offset:41472
    v_mfma_f32_16x16x32_bf16 v[84:87], v[188:191], v[232:235], v[84:87]
    v_mfma_f32_16x16x32_bf16 v[40:43], v[176:179], v[236:239], v[40:43]
    v_mfma_f32_16x16x32_bf16 v[44:47], v[180:183], v[236:239], v[44:47]
    v_mfma_f32_16x16x32_bf16 v[88:91], v[184:187], v[236:239], v[88:91]
    v_mfma_f32_16x16x32_bf16 v[92:95], v[188:191], v[236:239], v[92:95]
    s_waitcnt lgkmcnt(0)
    v_mfma_f32_16x16x32_bf16 v[0:3], v[192:195], v[160:163], v[0:3]
    ds_read_b128 v[176:179], v141 offset:16384
    v_mfma_f32_16x16x32_bf16 v[8:11], v[192:195], v[164:167], v[8:11]
    ds_read_b64_tr_b16 v[216:217], v154 offset:28672
    v_mfma_f32_16x16x32_bf16 v[48:51], v[192:195], v[168:171], v[48:51]
    ds_read_b64_tr_b16 v[218:219], v154 offset:29184
    v_mfma_f32_16x16x32_bf16 v[56:59], v[192:195], v[172:175], v[56:59]
    ds_read_b128 v[180:183], v143 offset:16384
    v_mfma_f32_16x16x32_bf16 v[4:7], v[196:199], v[160:163], v[4:7]
    ds_read_b64_tr_b16 v[220:221], v156 offset:28672
    v_mfma_f32_16x16x32_bf16 v[12:15], v[196:199], v[164:167], v[12:15]
    ds_read_b64_tr_b16 v[222:223], v156 offset:29184
    v_mfma_f32_16x16x32_bf16 v[52:55], v[196:199], v[168:171], v[52:55]
    ds_read_b128 v[184:187], v141 offset:20480
    v_mfma_f32_16x16x32_bf16 v[60:63], v[196:199], v[172:175], v[60:63]
    ds_read_b64_tr_b16 v[224:225], v154 offset:36864
    v_mfma_f32_16x16x32_bf16 v[16:19], v[200:203], v[160:163], v[16:19]
    ds_read_b64_tr_b16 v[226:227], v154 offset:37376
    v_mfma_f32_16x16x32_bf16 v[24:27], v[200:203], v[164:167], v[24:27]
    ds_read_b128 v[188:191], v143 offset:20480
    v_mfma_f32_16x16x32_bf16 v[64:67], v[200:203], v[168:171], v[64:67]
    ds_read_b64_tr_b16 v[228:229], v156 offset:36864
    v_mfma_f32_16x16x32_bf16 v[72:75], v[200:203], v[172:175], v[72:75]
    ds_read_b64_tr_b16 v[230:231], v156 offset:37376
    v_mfma_f32_16x16x32_bf16 v[20:23], v[204:207], v[160:163], v[20:23]
    ds_read_b64_tr_b16 v[232:233], v154 offset:45056
    v_mfma_f32_16x16x32_bf16 v[28:31], v[204:207], v[164:167], v[28:31]
    ds_read_b64_tr_b16 v[234:235], v154 offset:45568
    v_mfma_f32_16x16x32_bf16 v[68:71], v[204:207], v[168:171], v[68:71]
    ds_read_b64_tr_b16 v[236:237], v156 offset:45056
    v_mfma_f32_16x16x32_bf16 v[76:79], v[204:207], v[172:175], v[76:79]
    ds_read_b64_tr_b16 v[238:239], v156 offset:45568
    v_mfma_f32_16x16x32_bf16 v[32:35], v[160:163], v[208:211], v[32:35]
    v_mfma_f32_16x16x32_bf16 v[36:39], v[164:167], v[208:211], v[36:39]
    v_mfma_f32_16x16x32_bf16 v[80:83], v[168:171], v[208:211], v[80:83]
    v_mfma_f32_16x16x32_bf16 v[84:87], v[172:175], v[208:211], v[84:87]
    v_mfma_f32_16x16x32_bf16 v[40:43], v[160:163], v[212:215], v[40:43]
    v_mfma_f32_16x16x32_bf16 v[44:47], v[164:167], v[212:215], v[44:47]
    v_mfma_f32_16x16x32_bf16 v[88:91], v[168:171], v[212:215], v[88:91]
    v_mfma_f32_16x16x32_bf16 v[92:95], v[172:175], v[212:215], v[92:95]
    s_waitcnt lgkmcnt(0)
    v_mfma_f32_16x16x32_bf16 v[0:3], v[216:219], v[176:179], v[0:3]
    v_mfma_f32_16x16x32_bf16 v[8:11], v[216:219], v[180:183], v[8:11]
    v_mfma_f32_16x16x32_bf16 v[48:51], v[216:219], v[184:187], v[48:51]
    v_mfma_f32_16x16x32_bf16 v[56:59], v[216:219], v[188:191], v[56:59]
    s_barrier
    ds_read_b128 v[160:163], v140 offset:32768
    v_mfma_f32_16x16x32_bf16 v[4:7], v[220:223], v[176:179], v[4:7]
    ds_read_b64_tr_b16 v[192:193], v155 offset:0
    v_mfma_f32_16x16x32_bf16 v[12:15], v[220:223], v[180:183], v[12:15]
    ds_read_b64_tr_b16 v[194:195], v155 offset:512
    v_mfma_f32_16x16x32_bf16 v[52:55], v[220:223], v[184:187], v[52:55]
    ds_read_b128 v[164:167], v142 offset:32768
    v_mfma_f32_16x16x32_bf16 v[60:63], v[220:223], v[188:191], v[60:63]
    ds_read_b64_tr_b16 v[196:197], v157 offset:0
    v_mfma_f32_16x16x32_bf16 v[16:19], v[224:227], v[176:179], v[16:19]
    ds_read_b64_tr_b16 v[198:199], v157 offset:512
    v_mfma_f32_16x16x32_bf16 v[24:27], v[224:227], v[180:183], v[24:27]
    ds_read_b128 v[168:171], v140 offset:36864
    v_mfma_f32_16x16x32_bf16 v[64:67], v[224:227], v[184:187], v[64:67]
    ds_read_b64_tr_b16 v[200:201], v155 offset:8192
    v_mfma_f32_16x16x32_bf16 v[72:75], v[224:227], v[188:191], v[72:75]
    ds_read_b64_tr_b16 v[202:203], v155 offset:8704
    v_mfma_f32_16x16x32_bf16 v[20:23], v[228:231], v[176:179], v[20:23]
    ds_read_b128 v[172:175], v142 offset:36864
    v_mfma_f32_16x16x32_bf16 v[28:31], v[228:231], v[180:183], v[28:31]
    ds_read_b64_tr_b16 v[204:205], v157 offset:8192
    v_mfma_f32_16x16x32_bf16 v[68:71], v[228:231], v[184:187], v[68:71]
    ds_read_b64_tr_b16 v[206:207], v157 offset:8704
    v_mfma_f32_16x16x32_bf16 v[76:79], v[228:231], v[188:191], v[76:79]
    ds_read_b64_tr_b16 v[208:209], v155 offset:16384
    v_mfma_f32_16x16x32_bf16 v[32:35], v[176:179], v[232:235], v[32:35]
    ds_read_b64_tr_b16 v[210:211], v155 offset:16896
    v_mfma_f32_16x16x32_bf16 v[36:39], v[180:183], v[232:235], v[36:39]
    ds_read_b64_tr_b16 v[212:213], v157 offset:16384
    v_mfma_f32_16x16x32_bf16 v[80:83], v[184:187], v[232:235], v[80:83]
    ds_read_b64_tr_b16 v[214:215], v157 offset:16896
    v_mfma_f32_16x16x32_bf16 v[84:87], v[188:191], v[232:235], v[84:87]
    v_mfma_f32_16x16x32_bf16 v[40:43], v[176:179], v[236:239], v[40:43]
    v_mfma_f32_16x16x32_bf16 v[44:47], v[180:183], v[236:239], v[44:47]
    v_mfma_f32_16x16x32_bf16 v[88:91], v[184:187], v[236:239], v[88:91]
    v_mfma_f32_16x16x32_bf16 v[92:95], v[188:191], v[236:239], v[92:95]
    s_waitcnt lgkmcnt(0)
    v_mfma_f32_16x16x32_bf16 v[0:3], v[192:195], v[160:163], v[0:3]
    ds_read_b128 v[176:179], v141 offset:32768
    v_mfma_f32_16x16x32_bf16 v[8:11], v[192:195], v[164:167], v[8:11]
    ds_read_b64_tr_b16 v[216:217], v155 offset:4096
    v_mfma_f32_16x16x32_bf16 v[48:51], v[192:195], v[168:171], v[48:51]
    ds_read_b64_tr_b16 v[218:219], v155 offset:4608
    v_mfma_f32_16x16x32_bf16 v[56:59], v[192:195], v[172:175], v[56:59]
    ds_read_b128 v[180:183], v143 offset:32768
    v_mfma_f32_16x16x32_bf16 v[4:7], v[196:199], v[160:163], v[4:7]
    ds_read_b64_tr_b16 v[220:221], v157 offset:4096
    v_mfma_f32_16x16x32_bf16 v[12:15], v[196:199], v[164:167], v[12:15]
    ds_read_b64_tr_b16 v[222:223], v157 offset:4608
    v_mfma_f32_16x16x32_bf16 v[52:55], v[196:199], v[168:171], v[52:55]
    ds_read_b128 v[184:187], v141 offset:36864
    v_mfma_f32_16x16x32_bf16 v[60:63], v[196:199], v[172:175], v[60:63]
    ds_read_b64_tr_b16 v[224:225], v155 offset:12288
    v_mfma_f32_16x16x32_bf16 v[16:19], v[200:203], v[160:163], v[16:19]
    ds_read_b64_tr_b16 v[226:227], v155 offset:12800
    v_mfma_f32_16x16x32_bf16 v[24:27], v[200:203], v[164:167], v[24:27]
    ds_read_b128 v[188:191], v143 offset:36864
    v_mfma_f32_16x16x32_bf16 v[64:67], v[200:203], v[168:171], v[64:67]
    ds_read_b64_tr_b16 v[228:229], v157 offset:12288
    v_mfma_f32_16x16x32_bf16 v[72:75], v[200:203], v[172:175], v[72:75]
    ds_read_b64_tr_b16 v[230:231], v157 offset:12800
    v_mfma_f32_16x16x32_bf16 v[20:23], v[204:207], v[160:163], v[20:23]
    ds_read_b64_tr_b16 v[232:233], v155 offset:20480
    v_mfma_f32_16x16x32_bf16 v[28:31], v[204:207], v[164:167], v[28:31]
    ds_read_b64_tr_b16 v[234:235], v155 offset:20992
    v_mfma_f32_16x16x32_bf16 v[68:71], v[204:207], v[168:171], v[68:71]
    ds_read_b64_tr_b16 v[236:237], v157 offset:20480
    v_mfma_f32_16x16x32_bf16 v[76:79], v[204:207], v[172:175], v[76:79]
    ds_read_b64_tr_b16 v[238:239], v157 offset:20992
    v_mfma_f32_16x16x32_bf16 v[32:35], v[160:163], v[208:211], v[32:35]
    v_mfma_f32_16x16x32_bf16 v[36:39], v[164:167], v[208:211], v[36:39]
    v_mfma_f32_16x16x32_bf16 v[80:83], v[168:171], v[208:211], v[80:83]
    v_mfma_f32_16x16x32_bf16 v[84:87], v[172:175], v[208:211], v[84:87]
    v_mfma_f32_16x16x32_bf16 v[40:43], v[160:163], v[212:215], v[40:43]
    v_mfma_f32_16x16x32_bf16 v[44:47], v[164:167], v[212:215], v[44:47]
    v_mfma_f32_16x16x32_bf16 v[88:91], v[168:171], v[212:215], v[88:91]
    v_mfma_f32_16x16x32_bf16 v[92:95], v[172:175], v[212:215], v[92:95]
    s_waitcnt lgkmcnt(0)
    v_mfma_f32_16x16x32_bf16 v[0:3], v[216:219], v[176:179], v[0:3]
    v_mfma_f32_16x16x32_bf16 v[8:11], v[216:219], v[180:183], v[8:11]
    v_mfma_f32_16x16x32_bf16 v[48:51], v[216:219], v[184:187], v[48:51]
    v_mfma_f32_16x16x32_bf16 v[56:59], v[216:219], v[188:191], v[56:59]
    s_barrier
    ds_read_b128 v[160:163], v140 offset:49152
    v_mfma_f32_16x16x32_bf16 v[4:7], v[220:223], v[176:179], v[4:7]
    ds_read_b64_tr_b16 v[192:193], v155 offset:24576
    v_mfma_f32_16x16x32_bf16 v[12:15], v[220:223], v[180:183], v[12:15]
    ds_read_b64_tr_b16 v[194:195], v155 offset:25088
    v_mfma_f32_16x16x32_bf16 v[52:55], v[220:223], v[184:187], v[52:55]
    ds_read_b128 v[164:167], v142 offset:49152
    v_mfma_f32_16x16x32_bf16 v[60:63], v[220:223], v[188:191], v[60:63]
    ds_read_b64_tr_b16 v[196:197], v157 offset:24576
    v_mfma_f32_16x16x32_bf16 v[16:19], v[224:227], v[176:179], v[16:19]
    ds_read_b64_tr_b16 v[198:199], v157 offset:25088
    v_mfma_f32_16x16x32_bf16 v[24:27], v[224:227], v[180:183], v[24:27]
    ds_read_b128 v[168:171], v140 offset:53248
    v_mfma_f32_16x16x32_bf16 v[64:67], v[224:227], v[184:187], v[64:67]
    ds_read_b64_tr_b16 v[200:201], v155 offset:32768
    v_mfma_f32_16x16x32_bf16 v[72:75], v[224:227], v[188:191], v[72:75]
    ds_read_b64_tr_b16 v[202:203], v155 offset:33280
    v_mfma_f32_16x16x32_bf16 v[20:23], v[228:231], v[176:179], v[20:23]
    ds_read_b128 v[172:175], v142 offset:53248
    v_mfma_f32_16x16x32_bf16 v[28:31], v[228:231], v[180:183], v[28:31]
    ds_read_b64_tr_b16 v[204:205], v157 offset:32768
    v_mfma_f32_16x16x32_bf16 v[68:71], v[228:231], v[184:187], v[68:71]
    ds_read_b64_tr_b16 v[206:207], v157 offset:33280
    v_mfma_f32_16x16x32_bf16 v[76:79], v[228:231], v[188:191], v[76:79]
    ds_read_b64_tr_b16 v[208:209], v155 offset:40960
    v_mfma_f32_16x16x32_bf16 v[32:35], v[176:179], v[232:235], v[32:35]
    ds_read_b64_tr_b16 v[210:211], v155 offset:41472
    v_mfma_f32_16x16x32_bf16 v[36:39], v[180:183], v[232:235], v[36:39]
    ds_read_b64_tr_b16 v[212:213], v157 offset:40960
    v_mfma_f32_16x16x32_bf16 v[80:83], v[184:187], v[232:235], v[80:83]
    ds_read_b64_tr_b16 v[214:215], v157 offset:41472
    v_mfma_f32_16x16x32_bf16 v[84:87], v[188:191], v[232:235], v[84:87]
    v_mfma_f32_16x16x32_bf16 v[40:43], v[176:179], v[236:239], v[40:43]
    v_mfma_f32_16x16x32_bf16 v[44:47], v[180:183], v[236:239], v[44:47]
    v_mfma_f32_16x16x32_bf16 v[88:91], v[184:187], v[236:239], v[88:91]
    v_mfma_f32_16x16x32_bf16 v[92:95], v[188:191], v[236:239], v[92:95]
    s_waitcnt lgkmcnt(0)
    v_mfma_f32_16x16x32_bf16 v[0:3], v[192:195], v[160:163], v[0:3]
    ds_read_b128 v[176:179], v141 offset:49152
    v_mfma_f32_16x16x32_bf16 v[8:11], v[192:195], v[164:167], v[8:11]
    ds_read_b64_tr_b16 v[216:217], v155 offset:28672
    v_mfma_f32_16x16x32_bf16 v[48:51], v[192:195], v[168:171], v[48:51]
    ds_read_b64_tr_b16 v[218:219], v155 offset:29184
    v_mfma_f32_16x16x32_bf16 v[56:59], v[192:195], v[172:175], v[56:59]
    ds_read_b128 v[180:183], v143 offset:49152
    v_mfma_f32_16x16x32_bf16 v[4:7], v[196:199], v[160:163], v[4:7]
    ds_read_b64_tr_b16 v[220:221], v157 offset:28672
    v_mfma_f32_16x16x32_bf16 v[12:15], v[196:199], v[164:167], v[12:15]
    ds_read_b64_tr_b16 v[222:223], v157 offset:29184
    v_mfma_f32_16x16x32_bf16 v[52:55], v[196:199], v[168:171], v[52:55]
    ds_read_b128 v[184:187], v141 offset:53248
    v_mfma_f32_16x16x32_bf16 v[60:63], v[196:199], v[172:175], v[60:63]
    ds_read_b64_tr_b16 v[224:225], v155 offset:36864
    v_mfma_f32_16x16x32_bf16 v[16:19], v[200:203], v[160:163], v[16:19]
    ds_read_b64_tr_b16 v[226:227], v155 offset:37376
    v_mfma_f32_16x16x32_bf16 v[24:27], v[200:203], v[164:167], v[24:27]
    ds_read_b128 v[188:191], v143 offset:53248
    v_mfma_f32_16x16x32_bf16 v[64:67], v[200:203], v[168:171], v[64:67]
    ds_read_b64_tr_b16 v[228:229], v157 offset:36864
    v_mfma_f32_16x16x32_bf16 v[72:75], v[200:203], v[172:175], v[72:75]
    ds_read_b64_tr_b16 v[230:231], v157 offset:37376
    v_mfma_f32_16x16x32_bf16 v[20:23], v[204:207], v[160:163], v[20:23]
    ds_read_b64_tr_b16 v[232:233], v155 offset:45056
    v_mfma_f32_16x16x32_bf16 v[28:31], v[204:207], v[164:167], v[28:31]
    ds_read_b64_tr_b16 v[234:235], v155 offset:45568
    v_mfma_f32_16x16x32_bf16 v[68:71], v[204:207], v[168:171], v[68:71]
    ds_read_b64_tr_b16 v[236:237], v157 offset:45056
    v_mfma_f32_16x16x32_bf16 v[76:79], v[204:207], v[172:175], v[76:79]
    ds_read_b64_tr_b16 v[238:239], v157 offset:45568
    v_mfma_f32_16x16x32_bf16 v[32:35], v[160:163], v[208:211], v[32:35]
    v_mfma_f32_16x16x32_bf16 v[36:39], v[164:167], v[208:211], v[36:39]
    v_mfma_f32_16x16x32_bf16 v[80:83], v[168:171], v[208:211], v[80:83]
    v_mfma_f32_16x16x32_bf16 v[84:87], v[172:175], v[208:211], v[84:87]
    v_mfma_f32_16x16x32_bf16 v[40:43], v[160:163], v[212:215], v[40:43]
    v_mfma_f32_16x16x32_bf16 v[44:47], v[164:167], v[212:215], v[44:47]
    v_mfma_f32_16x16x32_bf16 v[88:91], v[168:171], v[212:215], v[88:91]
    v_mfma_f32_16x16x32_bf16 v[92:95], v[172:175], v[212:215], v[92:95]
    s_waitcnt lgkmcnt(0)
    v_mfma_f32_16x16x32_bf16 v[0:3], v[216:219], v[176:179], v[0:3]
    v_mfma_f32_16x16x32_bf16 v[8:11], v[216:219], v[180:183], v[8:11]
    v_mfma_f32_16x16x32_bf16 v[48:51], v[216:219], v[184:187], v[48:51]
    v_mfma_f32_16x16x32_bf16 v[56:59], v[216:219], v[188:191], v[56:59]
    s_sub_u32 s27, s27, 1
    s_cmp_eq_u32 s27, 0
    s_cbranch_scc1 K1_CTAIL
    s_barrier
    ds_read_b128 v[160:163], v140 offset:0
    v_mfma_f32_16x16x32_bf16 v[4:7], v[220:223], v[176:179], v[4:7]
    ds_read_b64_tr_b16 v[192:193], v154 offset:0
    v_mfma_f32_16x16x32_bf16 v[12:15], v[220:223], v[180:183], v[12:15]
    ds_read_b64_tr_b16 v[194:195], v154 offset:512
    v_mfma_f32_16x16x32_bf16 v[52:55], v[220:223], v[184:187], v[52:55]
    ds_read_b128 v[164:167], v142 offset:0
    v_mfma_f32_16x16x32_bf16 v[60:63], v[220:223], v[188:191], v[60:63]
    ds_read_b64_tr_b16 v[196:197], v156 offset:0
    v_mfma_f32_16x16x32_bf16 v[16:19], v[224:227], v[176:179], v[16:19]
    ds_read_b64_tr_b16 v[198:199], v156 offset:512
    v_mfma_f32_16x16x32_bf16 v[24:27], v[224:227], v[180:183], v[24:27]
    ds_read_b128 v[168:171], v140 offset:4096
    v_mfma_f32_16x16x32_bf16 v[64:67], v[224:227], v[184:187], v[64:67]
    ds_read_b64_tr_b16 v[200:201], v154 offset:8192
    v_mfma_f32_16x16x32_bf16 v[72:75], v[224:227], v[188:191], v[72:75]
    ds_read_b64_tr_b16 v[202:203], v154 offset:8704
    v_mfma_f32_16x16x32_bf16 v[20:23], v[228:231], v[176:179], v[20:23]
    ds_read_b128 v[172:175], v142 offset:4096
    v_mfma_f32_16x16x32_bf16 v[28:31], v[228:231], v[180:183], v[28:31]
    ds_read_b64_tr_b16 v[204:205], v156 offset:8192
    v_mfma_f32_16x16x32_bf16 v[68:71], v[228:231], v[184:187], v[68:71]
    ds_read_b64_tr_b16 v[206:207], v156 offset:8704
    v_mfma_f32_16x16x32_bf16 v[76:79], v[228:231], v[188:191], v[76:79]
    ds_read_b64_tr_b16 v[208:209], v154 offset:16384
    v_mfma_f32_16x16x32_bf16 v[32:35], v[176:179], v[232:235], v[32:35]
    ds_read_b64_tr_b16 v[210:211], v154 offset:16896
    v_mfma_f32_16x16x32_bf16 v[36:39], v[180:183], v[232:235], v[36:39]
    ds_read_b64_tr_b16 v[212:213], v156 offset:16384
    v_mfma_f32_16x16x32_bf16 v[80:83], v[184:187], v[232:235], v[80:83]
    ds_read_b64_tr_b16 v[214:215], v156 offset:16896
    v_mfma_f32_16x16x32_bf16 v[84:87], v[188:191], v[232:235], v[84:87]
    v_mfma_f32_16x16x32_bf16 v[40:43], v[176:179], v[236:239], v[40:43]
    v_mfma_f32_16x16x32_bf16 v[44:47], v[180:183], v[236:239], v[44:47]
    v_mfma_f32_16x16x32_bf16 v[88:91], v[184:187], v[236:239], v[88:91]
    v_mfma_f32_16x16x32_bf16 v[92:95], v[188:191], v[236:239], v[92:95]
    s_branch K1_CLOOP
K1_CTAIL:
    v_mfma_f32_16x16x32_bf16 v[4:7], v[220:223], v[176:179], v[4:7]
    v_mfma_f32_16x16x32_bf16 v[12:15], v[220:223], v[180:183], v[12:15]
    v_mfma_f32_16x16x32_bf16 v[52:55], v[220:223], v[184:187], v[52:55]
    v_mfma_f32_16x16x32_bf16 v[60:63], v[220:223], v[188:191], v[60:63]
    v_mfma_f32_16x16x32_bf16 v[16:19], v[224:227], v[176:179], v[16:19]
    v_mfma_f32_16x16x32_bf16 v[24:27], v[224:227], v[180:183], v[24:27]
    v_mfma_f32_16x16x32_bf16 v[64:67], v[224:227], v[184:187], v[64:67]
    v_mfma_f32_16x16x32_bf16 v[72:75], v[224:227], v[188:191], v[72:75]
    v_mfma_f32_16x16x32_bf16 v[20:23], v[228:231], v[176:179], v[20:23]
    v_mfma_f32_16x16x32_bf16 v[28:31], v[228:231], v[180:183], v[28:31]
    v_mfma_f32_16x16x32_bf16 v[68:71], v[228:231], v[184:187], v[68:71]
    v_mfma_f32_16x16x32_bf16 v[76:79], v[228:231], v[188:191], v[76:79]
    v_mfma_f32_16x16x32_bf16 v[32:35], v[176:179], v[232:235], v[32:35]
    v_mfma_f32_16x16x32_bf16 v[36:39], v[180:183], v[232:235], v[36:39]
    v_mfma_f32_16x16x32_bf16 v[80:83], v[184:187], v[232:235], v[80:83]
    v_mfma_f32_16x16x32_bf16 v[84:87], v[188:191], v[232:235], v[84:87]
    v_mfma_f32_16x16x32_bf16 v[40:43], v[176:179], v[236:239], v[40:43]
    v_mfma_f32_16x16x32_bf16 v[44:47], v[180:183], v[236:239], v[44:47]
    v_mfma_f32_16x16x32_bf16 v[88:91], v[184:187], v[236:239], v[88:91]
    v_mfma_f32_16x16x32_bf16 v[92:95], v[188:191], v[236:239], v[92:95]
    s_lshl_b32 s28, s5, 1
    s_add_u32 s28, s28, s25
    s_lshl_b32 s28, s28, 6
    s_lshl_b32 s29, s4, 2
    s_add_u32 s28, s28, s29
    s_lshl_b32 s29, s24, 1
    s_add_u32 s28, s28, s29
    s_lshl_b32 s29, s28, 11
    s_lshl_b32 s30, s28, 12
    s_add_u32 s30, s30, 4194304
    s_add_u32 s31, s30, 4096
    s_mov_b32 s32, 0x3e8293ee
    v_mul_f32 v0, s32, v0
    v_mul_f32 v1, s32, v1
    v_mul_f32 v2, s32, v2
    v_mul_f32 v3, s32, v3
    v_mul_f32 v4, s32, v4
    v_mul_f32 v5, s32, v5
    v_mul_f32 v6, s32, v6
    v_mul_f32 v7, s32, v7
    v_mul_f32 v8, s32, v8
    v_mul_f32 v9, s32, v9
    v_mul_f32 v10, s32, v10
    v_mul_f32 v11, s32, v11
    v_mul_f32 v12, s32, v12
    v_mul_f32 v13, s32, v13
    v_mul_f32 v14, s32, v14
    v_mul_f32 v15, s32, v15
    v_cvt_pk_bf16_f32 v100, v0, v1
    v_cvt_pk_bf16_f32 v101, v2, v3
    v_cvt_pk_bf16_f32 v102, v4, v5
    v_cvt_pk_bf16_f32 v103, v6, v7
    buffer_store_dwordx4 v[100:103], v132, s[16:19], s29 offen offset:0
    v_cvt_pk_bf16_f32 v104, v8, v9
    v_cvt_pk_bf16_f32 v105, v10, v11
    v_cvt_pk_bf16_f32 v106, v12, v13
    v_cvt_pk_bf16_f32 v107, v14, v15
    buffer_store_dwordx4 v[104:107], v133, s[16:19], s29 offen offset:0
    v_mul_f32 v48, s32, v48
    v_mul_f32 v49, s32, v49
    v_mul_f32 v50, s32, v50
    v_mul_f32 v51, s32, v51
    v_mul_f32 v52, s32, v52
    v_mul_f32 v53, s32, v53
    v_mul_f32 v54, s32, v54
    v_mul_f32 v55, s32, v55
    v_mul_f32 v56, s32, v56
    v_mul_f32 v57, s32, v57
    v_mul_f32 v58, s32, v58
    v_mul_f32 v59, s32, v59
    v_mul_f32 v60, s32, v60
    v_mul_f32 v61, s32, v61
    v_mul_f32 v62, s32, v62
    v_mul_f32 v63, s32, v63
    v_cvt_pk_bf16_f32 v108, v48, v49
    v_cvt_pk_bf16_f32 v109, v50, v51
    v_cvt_pk_bf16_f32 v110, v52, v53
    v_cvt_pk_bf16_f32 v111, v54, v55
    buffer_store_dwordx4 v[108:111], v132, s[16:19], s29 offen offset:2048
    v_cvt_pk_bf16_f32 v112, v56, v57
    v_cvt_pk_bf16_f32 v113, v58, v59
    v_cvt_pk_bf16_f32 v114, v60, v61
    v_cvt_pk_bf16_f32 v115, v62, v63
    buffer_store_dwordx4 v[112:115], v133, s[16:19], s29 offen offset:2048
    v_cvt_pk_bf16_f32 v116, v16, v17
    v_cvt_pk_bf16_f32 v117, v18, v19
    v_cvt_pk_bf16_f32 v118, v20, v21
    v_cvt_pk_bf16_f32 v119, v22, v23
    buffer_store_dwordx4 v[116:119], v134, s[16:19], s30 offen offset:0
    v_cvt_pk_bf16_f32 v120, v24, v25
    v_cvt_pk_bf16_f32 v121, v26, v27
    v_cvt_pk_bf16_f32 v122, v28, v29
    v_cvt_pk_bf16_f32 v123, v30, v31
    buffer_store_dwordx4 v[120:123], v134, s[16:19], s30 offen offset:64
    v_cvt_pk_bf16_f32 v124, v64, v65
    v_cvt_pk_bf16_f32 v125, v66, v67
    v_cvt_pk_bf16_f32 v126, v68, v69
    v_cvt_pk_bf16_f32 v127, v70, v71
    buffer_store_dwordx4 v[124:127], v134, s[16:19], s31 offen offset:0
    v_cvt_pk_bf16_f32 v128, v72, v73
    v_cvt_pk_bf16_f32 v129, v74, v75
    v_cvt_pk_bf16_f32 v130, v76, v77
    v_cvt_pk_bf16_f32 v131, v78, v79
    buffer_store_dwordx4 v[128:131], v134, s[16:19], s31 offen offset:64
    v_cvt_pk_bf16_f32 v100, v32, v33
    v_cvt_pk_bf16_f32 v101, v34, v35
    v_cvt_pk_bf16_f32 v102, v36, v37
    v_cvt_pk_bf16_f32 v103, v38, v39
    buffer_store_dwordx4 v[100:103], v135, s[16:19], s30 offen offset:2048
    v_cvt_pk_bf16_f32 v104, v40, v41
    v_cvt_pk_bf16_f32 v105, v42, v43
    v_cvt_pk_bf16_f32 v106, v44, v45
    v_cvt_pk_bf16_f32 v107, v46, v47
    buffer_store_dwordx4 v[104:107], v135, s[16:19], s30 offen offset:2304
    v_cvt_pk_bf16_f32 v108, v80, v81
    v_cvt_pk_bf16_f32 v109, v82, v83
    v_cvt_pk_bf16_f32 v110, v84, v85
    v_cvt_pk_bf16_f32 v111, v86, v87
    buffer_store_dwordx4 v[108:111], v135, s[16:19], s31 offen offset:2048
    v_cvt_pk_bf16_f32 v112, v88, v89
    v_cvt_pk_bf16_f32 v113, v90, v91
    v_cvt_pk_bf16_f32 v114, v92, v93
    v_cvt_pk_bf16_f32 v115, v94, v95
    buffer_store_dwordx4 v[112:115], v135, s[16:19], s31 offen offset:2304
    s_endpgm
.p2align 6
K1_PROD:
    s_sub_u32 s24, s3, 4
    v_lshrrev_b32 v88, 3, v99
    v_and_b32 v89, 7, v99
    v_lshrrev_b32 v90, 4, v99
    v_xor_b32 v91, v89, v90
    v_lshlrev_b32 v91, 4, v91
    v_lshl_or_b32 v91, v88, 11, v91
    s_lshl_b32 s25, s4, 18
    s_lshl_b32 s26, s24, 16
    s_add_u32 s25, s25, s26
    v_add_u32 v100, s25, v91
    v_xor_b32 v101, 64, v100
    v_add_u32 v101, 15360, v101
    v_add_u32 v102, 30720, v100
    v_add_u32 v103, 30720, v101
    v_and_b32 v90, 1, v90
    v_lshlrev_b32 v90, 2, v90
    v_xor_b32 v91, v89, v90
    v_lshlrev_b32 v91, 4, v91
    s_movk_i32 s26, 6144
    v_mad_u32_u24 v91, v88, s26, v91
    v_xor_b32 v92, 32, v91
    s_lshl_b32 s27, s5, 7
    s_mul_i32 s28, s24, 6
    s_add_u32 s29, s28, 0
    s_and_b32 s30, s29, 7
    s_mul_i32 s30, s30, 49152
    s_lshr_b32 s29, s29, 3
    s_lshl_b32 s29, s29, 11
    s_add_u32 s29, s29, s30
    s_add_u32 s29, s29, s27
    s_sub_u32 s29, s29, 0
    v_add_u32 v104, s29, v91
    s_add_u32 s29, s28, 1
    s_and_b32 s30, s29, 7
    s_mul_i32 s30, s30, 49152
    s_lshr_b32 s29, s29, 3
    s_lshl_b32 s29, s29, 11
    s_add_u32 s29, s29, s30
    s_add_u32 s29, s29, s27
    s_sub_u32 s29, s29, 1024
    v_add_u32 v105, s29, v92
    s_add_u32 s29, s28, 2
    s_and_b32 s30, s29, 7
    s_mul_i32 s30, s30, 49152
    s_lshr_b32 s29, s29, 3
    s_lshl_b32 s29, s29, 11
    s_add_u32 s29, s29, s30
    s_add_u32 s29, s29, s27
    s_sub_u32 s29, s29, 2048
    v_add_u32 v106, s29, v91
    s_add_u32 s29, s28, 3
    s_and_b32 s30, s29, 7
    s_mul_i32 s30, s30, 49152
    s_lshr_b32 s29, s29, 3
    s_lshl_b32 s29, s29, 11
    s_add_u32 s29, s29, s30
    s_add_u32 s29, s29, s27
    s_sub_u32 s29, s29, 0
    v_add_u32 v107, s29, v92
    s_add_u32 s29, s28, 4
    s_and_b32 s30, s29, 7
    s_mul_i32 s30, s30, 49152
    s_lshr_b32 s29, s29, 3
    s_lshl_b32 s29, s29, 11
    s_add_u32 s29, s29, s30
    s_add_u32 s29, s29, s27
    s_sub_u32 s29, s29, 1024
    v_add_u32 v108, s29, v91
    s_add_u32 s29, s28, 5
    s_and_b32 s30, s29, 7
    s_mul_i32 s30, s30, 49152
    s_lshr_b32 s29, s29, 3
    s_lshl_b32 s29, s29, 11
    s_add_u32 s29, s29, s30
    s_add_u32 s29, s29, s27
    s_sub_u32 s29, s29, 2048
    v_add_u32 v109, s29, v92
    s_lshl_b32 s41, s4, 1
    s_and_b32 s41, s41, 15
    s_lshl_b32 s40, s41, 7
    s_mul_i32 s41, s41, 393216
    s_lshl_b32 s42, s24, 12
    s_mul_i32 s43, s24, 6144
    s_add_u32 s43, s43, 0x10000
    s_mov_b32 s44, s42
    s_mov_b32 s45, s43
    s_add_u32 s46, s42, 0x10000
    s_waitcnt lgkmcnt(0)
    s_mov_b32 m0, s42
    s_add_u32 s47, s43, 3072
    buffer_load_dwordx4 v100, s[8:11], s40 offen lds
    s_and_b32 s50, s2, 7
    buffer_load_dwordx4 v101, s[8:11], s40 offen offset:1024 lds
    s_lshl_b32 s50, s50, 2
    s_add_u32 s50, s50, s24
    buffer_load_dwordx4 v102, s[8:11], s40 offen offset:2048 lds
    s_lshl_b32 s50, s50, 5
    s_lshr_b32 s51, s2, 3
    buffer_load_dwordx4 v103, s[8:11], s40 offen offset:3072 lds
    s_add_u32 s50, s50, s51
    s_sub_u32 s51, 2048, s50
    s_mov_b32 m0, s43
    s_add_u32 s42, s42, 16384
    buffer_load_dwordx4 v104, s[12:15], s41 offen offset:0 lds
    s_cmp_eq_u32 s50, 0
    s_cselect_b32 s51, 1024, s51
    buffer_load_dwordx4 v105, s[12:15], s41 offen offset:1024 lds
    s_mov_b32 s52, -1.0
    s_mov_b32 s54, 15730688
    buffer_load_dwordx4 v106, s[12:15], s41 offen offset:2048 lds
    s_add_u32 s53, s44, 49152
    s_lshl_b32 s55, s50, 11
    s_mov_b32 m0, s47
    s_add_u32 s43, s43, 24576
    buffer_load_dwordx4 v107, s[12:15], s41 offen offset:0 lds
    s_lshl_b32 s56, s51, 11
    s_sub_u32 s56, s56, 2048
    buffer_load_dwordx4 v108, s[12:15], s41 offen offset:1024 lds
    v_lshlrev_b32 v90, 4, v99
    v_and_b32 v88, 31, v99
    buffer_load_dwordx4 v109, s[12:15], s41 offen offset:2048 lds
    s_add_u32 s40, s40, 128
    s_add_u32 s41, s41, 393216
    s_cmp_eq_u32 s40, 2048
    s_cselect_b32 s40, 0, s40
    s_cselect_b32 s41, 0, s41
    s_cmp_eq_u32 s42, s46
    s_cselect_b32 s42, s44, s42
    s_cselect_b32 s43, s45, s43
    v_lshrrev_b32 v89, 5, v99
    v_lshlrev_b32 v96, 4, v88
    s_mov_b32 m0, s42
    s_add_u32 s47, s43, 3072
    buffer_load_dwordx4 v100, s[8:11], s40 offen lds
    buffer_load_dwordx4 v101, s[8:11], s40 offen offset:1024 lds
    buffer_load_dwordx4 v102, s[8:11], s40 offen offset:2048 lds
    buffer_load_dwordx4 v103, s[8:11], s40 offen offset:3072 lds
    v_mov_b64 v[0:1], 0
    v_mov_b64 v[2:3], 0
    v_mov_b64 v[4:5], 0
    v_mov_b64 v[6:7], 0
    v_mov_b64 v[8:9], 0
    v_mov_b64 v[10:11], 0
    v_mov_b64 v[12:13], 0
    v_mov_b64 v[14:15], 0
    v_mov_b64 v[16:17], 0
    v_mov_b64 v[18:19], 0
    v_mov_b64 v[20:21], 0
    v_mov_b64 v[22:23], 0
    v_mov_b64 v[24:25], 0
    v_mov_b64 v[26:27], 0
    v_mov_b64 v[28:29], 0
    v_mov_b64 v[30:31], 0
    v_lshlrev_b32 v98, 1, v88
    v_lshl_or_b32 v98, v89, 9, v98
    v_add_u32 v208, s53, v98
    s_add_u32 s57, s53, 2624
    v_sub_u32 v94, s57, v98
    v_cmp_eq_u32 vcc, 0, v99
    v_subrev_u32 v98, 2048, v94
    v_lshl_or_b32 v209, v89, 11, v96
    v_cndmask_b32 v95, v94, v98, vcc
    v_add_u32 v209, s53, v209
    v_lshlrev_b32 v97, 6, v88
    v_lshl_or_b32 v97, v89, 4, v97
    v_and_b32 v98, 0x13, v88
    v_bfe_u32 v92, v88, 2, 1
    v_lshl_or_b32 v98, v92, 3, v98
    v_bfe_u32 v92, v88, 3, 1
    v_lshl_or_b32 v98, v92, 2, v98
    v_cvt_f32_u32 v98, v98
    v_cvt_f32_u32 v93, v89
    v_mul_f32 v91, 0xbd000000, v98
    v_mul_f32 v92, v91, v93
    v_mul_f32 v92, 0x41000000, v92
    v_cos_f32 v176, v92
    v_sin_f32 v177, v92
    v_fmamk_f32 v184, v91, 0x3f800000, v92
    v_cos_f32 v178, v184
    v_sin_f32 v179, v184
    v_cvt_pk_bf16_f32 v40, v176, v178
    v_cvt_pk_bf16_f32 v48, v177, v179
    v_fmamk_f32 v184, v91, 0x40000000, v92
    v_cos_f32 v180, v184
    v_sin_f32 v181, v184
    v_fmamk_f32 v184, v91, 0x40400000, v92
    v_cos_f32 v182, v184
    v_sin_f32 v183, v184
    v_cvt_pk_bf16_f32 v41, v180, v182
    v_cvt_pk_bf16_f32 v49, v181, v183
    v_fmamk_f32 v184, v91, 0x40800000, v92
    v_cos_f32 v176, v184
    v_sin_f32 v177, v184
    v_fmamk_f32 v184, v91, 0x40a00000, v92
    v_cos_f32 v178, v184
    v_sin_f32 v179, v184
    v_cvt_pk_bf16_f32 v42, v176, v178
    v_cvt_pk_bf16_f32 v50, v177, v179
    v_fmamk_f32 v184, v91, 0x40c00000, v92
    v_cos_f32 v180, v184
    v_sin_f32 v181, v184
    v_fmamk_f32 v184, v91, 0x40e00000, v92
    v_cos_f32 v182, v184
    v_sin_f32 v183, v184
    v_cvt_pk_bf16_f32 v43, v180, v182
    v_cvt_pk_bf16_f32 v51, v181, v183
    v_fmamk_f32 v184, v91, 0x41800000, v92
    v_cos_f32 v176, v184
    v_sin_f32 v177, v184
    v_fmamk_f32 v184, v91, 0x41880000, v92
    v_cos_f32 v178, v184
    v_sin_f32 v179, v184
    v_cvt_pk_bf16_f32 v44, v176, v178
    v_cvt_pk_bf16_f32 v52, v177, v179
    v_fmamk_f32 v184, v91, 0x41900000, v92
    v_cos_f32 v180, v184
    v_sin_f32 v181, v184
    v_fmamk_f32 v184, v91, 0x41980000, v92
    v_cos_f32 v182, v184
    v_sin_f32 v183, v184
    v_cvt_pk_bf16_f32 v45, v180, v182
    v_cvt_pk_bf16_f32 v53, v181, v183
    v_fmamk_f32 v184, v91, 0x41a00000, v92
    v_cos_f32 v176, v184
    v_sin_f32 v177, v184
    v_fmamk_f32 v184, v91, 0x41a80000, v92
    v_cos_f32 v178, v184
    v_sin_f32 v179, v184
    v_cvt_pk_bf16_f32 v46, v176, v178
    v_cvt_pk_bf16_f32 v54, v177, v179
    v_fmamk_f32 v184, v91, 0x41b00000, v92
    v_cos_f32 v180, v184
    v_sin_f32 v181, v184
    v_fmamk_f32 v184, v91, 0x41b80000, v92
    v_cos_f32 v182, v184
    v_sin_f32 v183, v184
    v_cvt_pk_bf16_f32 v47, v180, v182
    v_cvt_pk_bf16_f32 v55, v181, v183
    v_mul_f32 v91, 0x3a800000, v98
    v_mul_f32 v92, v91, v93
    v_mul_f32 v92, 4.0, v92
    v_cos_f32 v112, v92
    v_sin_f32 v128, v92
    v_fmamk_f32 v184, v91, 0x3f800000, v92
    v_cos_f32 v113, v184
    v_sin_f32 v129, v184
    v_fmamk_f32 v184, v91, 0x40000000, v92
    v_cos_f32 v114, v184
    v_sin_f32 v130, v184
    v_fmamk_f32 v184, v91, 0x40400000, v92
    v_cos_f32 v115, v184
    v_sin_f32 v131, v184
    v_fmamk_f32 v184, v91, 0x41000000, v92
    v_cos_f32 v116, v184
    v_sin_f32 v132, v184
    v_fmamk_f32 v184, v91, 0x41100000, v92
    v_cos_f32 v117, v184
    v_sin_f32 v133, v184
    v_fmamk_f32 v184, v91, 0x41200000, v92
    v_cos_f32 v118, v184
    v_sin_f32 v134, v184
    v_fmamk_f32 v184, v91, 0x41300000, v92
    v_cos_f32 v119, v184
    v_sin_f32 v135, v184
    v_fmamk_f32 v184, v91, 0x41800000, v92
    v_cos_f32 v120, v184
    v_sin_f32 v136, v184
    v_fmamk_f32 v184, v91, 0x41880000, v92
    v_cos_f32 v121, v184
    v_sin_f32 v137, v184
    v_fmamk_f32 v184, v91, 0x41900000, v92
    v_cos_f32 v122, v184
    v_sin_f32 v138, v184
    v_fmamk_f32 v184, v91, 0x41980000, v92
    v_cos_f32 v123, v184
    v_sin_f32 v139, v184
    v_fmamk_f32 v184, v91, 0x41c00000, v92
    v_cos_f32 v124, v184
    v_sin_f32 v140, v184
    v_fmamk_f32 v184, v91, 0x41c80000, v92
    v_cos_f32 v125, v184
    v_sin_f32 v141, v184
    v_fmamk_f32 v184, v91, 0x41d00000, v92
    v_cos_f32 v126, v184
    v_sin_f32 v142, v184
    v_fmamk_f32 v184, v91, 0x41d80000, v92
    v_cos_f32 v127, v184
    v_sin_f32 v143, v184
    v_and_b32 v98, 15, v88
    v_cvt_f32_u32 v98, v98
    v_mul_f32 v91, 0x3d000000, v98
    v_mul_f32 v92, v91, v93
    v_mul_f32 v92, 4.0, v92
    v_lshrrev_b32 v98, 4, v88
    v_cvt_f32_u32 v98, v98
    v_fmamk_f32 v92, v98, 0x3e800000, v92
    v_cos_f32 v176, v92
    v_sin_f32 v177, v92
    v_fmamk_f32 v184, v91, 0x3f800000, v92
    v_cos_f32 v178, v184
    v_sin_f32 v179, v184
    v_cvt_pk_bf16_f32 v56, v176, v178
    v_cvt_pk_bf16_f32 v64, v177, v179
    v_fmamk_f32 v184, v91, 0x40000000, v92
    v_cos_f32 v180, v184
    v_sin_f32 v181, v184
    v_fmamk_f32 v184, v91, 0x40400000, v92
    v_cos_f32 v182, v184
    v_sin_f32 v183, v184
    v_cvt_pk_bf16_f32 v57, v180, v182
    v_cvt_pk_bf16_f32 v65, v181, v183
    v_fmamk_f32 v184, v91, 0x41000000, v92
    v_cos_f32 v176, v184
    v_sin_f32 v177, v184
    v_fmamk_f32 v184, v91, 0x41100000, v92
    v_cos_f32 v178, v184
    v_sin_f32 v179, v184
    v_cvt_pk_bf16_f32 v58, v176, v178
    v_cvt_pk_bf16_f32 v66, v177, v179
    v_fmamk_f32 v184, v91, 0x41200000, v92
    v_cos_f32 v180, v184
    v_sin_f32 v181, v184
    v_fmamk_f32 v184, v91, 0x41300000, v92
    v_cos_f32 v182, v184
    v_sin_f32 v183, v184
    v_cvt_pk_bf16_f32 v59, v180, v182
    v_cvt_pk_bf16_f32 v67, v181, v183
    v_fmamk_f32 v184, v91, 0x41800000, v92
    v_cos_f32 v176, v184
    v_sin_f32 v177, v184
    v_fmamk_f32 v184, v91, 0x41880000, v92
    v_cos_f32 v178, v184
    v_sin_f32 v179, v184
    v_cvt_pk_bf16_f32 v60, v176, v178
    v_cvt_pk_bf16_f32 v68, v177, v179
    v_fmamk_f32 v184, v91, 0x41900000, v92
    v_cos_f32 v180, v184
    v_sin_f32 v181, v184
    v_fmamk_f32 v184, v91, 0x41980000, v92
    v_cos_f32 v182, v184
    v_sin_f32 v183, v184
    v_cvt_pk_bf16_f32 v61, v180, v182
    v_cvt_pk_bf16_f32 v69, v181, v183
    v_fmamk_f32 v184, v91, 0x41c00000, v92
    v_cos_f32 v176, v184
    v_sin_f32 v177, v184
    v_fmamk_f32 v184, v91, 0x41c80000, v92
    v_cos_f32 v178, v184
    v_sin_f32 v179, v184
    v_cvt_pk_bf16_f32 v62, v176, v178
    v_cvt_pk_bf16_f32 v70, v177, v179
    v_fmamk_f32 v184, v91, 0x41d00000, v92
    v_cos_f32 v180, v184
    v_sin_f32 v181, v184
    v_fmamk_f32 v184, v91, 0x41d80000, v92
    v_cos_f32 v182, v184
    v_sin_f32 v183, v184
    v_cvt_pk_bf16_f32 v63, v180, v182
    v_cvt_pk_bf16_f32 v71, v181, v183
    s_waitcnt vmcnt(4)
    s_barrier
    s_mov_b32 m0, s43
    s_add_u32 s42, s42, 16384
    buffer_load_dwordx4 v104, s[12:15], s41 offen offset:0 lds
    buffer_load_dwordx4 v105, s[12:15], s41 offen offset:1024 lds
    buffer_load_dwordx4 v106, s[12:15], s41 offen offset:2048 lds
    s_mov_b32 m0, s47
    s_add_u32 s43, s43, 24576
    buffer_load_dwordx4 v107, s[12:15], s41 offen offset:0 lds
    buffer_load_dwordx4 v108, s[12:15], s41 offen offset:1024 lds
    buffer_load_dwordx4 v109, s[12:15], s41 offen offset:2048 lds
    s_add_u32 s40, s40, 128
    s_add_u32 s41, s41, 393216
    s_cmp_eq_u32 s40, 2048
    s_cselect_b32 s40, 0, s40
    s_cselect_b32 s41, 0, s41
    s_cmp_eq_u32 s42, s46
    s_cselect_b32 s42, s44, s42
    s_cselect_b32 s43, s45, s43
    s_mov_b32 m0, s53
    s_nop 0
    buffer_load_dwordx4 v90, s[8:11], s55 offen lds
    buffer_load_dwordx4 v90, s[8:11], s55 offen offset:1024 lds
    buffer_load_dwordx4 v90, s[8:11], s56 offen offset:2048 lds
    buffer_load_dwordx4 v90, s[8:11], s56 offen offset:3072 lds
    buffer_load_dwordx4 v[240:243], v96, s[20:23], 0 offen offset:0
    buffer_load_dwordx4 v[244:247], v96, s[20:23], 0 offen offset:512
    buffer_load_dwordx4 v[248:251], v96, s[20:23], 0 offen offset:1024
    buffer_load_dwordx4 v[252:255], v96, s[20:23], 0 offen offset:1536
    s_waitcnt vmcnt(8)
    s_barrier
    s_mov_b32 m0, s42
    s_add_u32 s47, s43, 3072
    buffer_load_dwordx4 v100, s[8:11], s40 offen lds
    buffer_load_dwordx4 v101, s[8:11], s40 offen offset:1024 lds
    buffer_load_dwordx4 v102, s[8:11], s40 offen offset:2048 lds
    buffer_load_dwordx4 v103, s[8:11], s40 offen offset:3072 lds
    s_mov_b32 m0, s43
    s_add_u32 s42, s42, 16384
    buffer_load_dwordx4 v104, s[12:15], s41 offen offset:0 lds
    buffer_load_dwordx4 v105, s[12:15], s41 offen offset:1024 lds
    buffer_load_dwordx4 v106, s[12:15], s41 offen offset:2048 lds
    s_mov_b32 m0, s47
    s_add_u32 s43, s43, 24576
    buffer_load_dwordx4 v107, s[12:15], s41 offen offset:0 lds
    buffer_load_dwordx4 v108, s[12:15], s41 offen offset:1024 lds
    buffer_load_dwordx4 v109, s[12:15], s41 offen offset:2048 lds
    s_add_u32 s40, s40, 128
    s_add_u32 s41, s41, 393216
    s_cmp_eq_u32 s40, 2048
    s_cselect_b32 s40, 0, s40
    s_cselect_b32 s41, 0, s41
    s_cmp_eq_u32 s42, s46
    s_cselect_b32 s42, s44, s42
    s_cselect_b32 s43, s45, s43
    s_waitcnt vmcnt(10)
    ds_read_u16_d16_hi v0, v208 offset:0
    ds_read_u16_d16_hi v16, v95 offset:1472
    ds_read_u16_d16_hi v1, v208 offset:64
    ds_read_u16_d16_hi v17, v94 offset:1408
    ds_read_u16_d16_hi v2, v208 offset:128
    ds_read_u16_d16_hi v18, v94 offset:1344
    ds_read_u16_d16_hi v3, v208 offset:192
    ds_read_u16_d16_hi v19, v94 offset:1280
    ds_read_u16_d16_hi v4, v208 offset:256
    ds_read_u16_d16_hi v20, v94 offset:1216
    ds_read_u16_d16_hi v5, v208 offset:320
    ds_read_u16_d16_hi v21, v94 offset:1152
    ds_read_u16_d16_hi v6, v208 offset:384
    ds_read_u16_d16_hi v22, v94 offset:1088
    ds_read_u16_d16_hi v7, v208 offset:448
    ds_read_u16_d16_hi v23, v94 offset:1024
    ds_read_u16_d16_hi v8, v208 offset:1024
    ds_read_u16_d16_hi v24, v94 offset:448
    ds_read_u16_d16_hi v9, v208 offset:1088
    ds_read_u16_d16_hi v25, v94 offset:384
    ds_read_u16_d16_hi v10, v208 offset:1152
    ds_read_u16_d16_hi v26, v94 offset:320
    ds_read_u16_d16_hi v11, v208 offset:1216
    ds_read_u16_d16_hi v27, v94 offset:256
    ds_read_u16_d16_hi v12, v208 offset:1280
    ds_read_u16_d16_hi v28, v94 offset:192
    ds_read_u16_d16_hi v13, v208 offset:1344
    ds_read_u16_d16_hi v29, v94 offset:128
    ds_read_u16_d16_hi v14, v208 offset:1408
    ds_read_u16_d16_hi v30, v94 offset:64
    ds_read_u16_d16_hi v15, v208 offset:1472
    ds_read_u16_d16_hi v31, v94 offset:0
    ds_read_b128 v[224:227], v209 offset:0
    ds_read_b128 v[228:231], v209 offset:512
    ds_read_b128 v[232:235], v209 offset:1024
    ds_read_b128 v[236:239], v209 offset:1536
    s_waitcnt lgkmcnt(0)
    s_mov_b32 m0, s42
    s_add_u32 s47, s43, 3072
    buffer_load_dwordx4 v100, s[8:11], s40 offen lds
    buffer_load_dwordx4 v101, s[8:11], s40 offen offset:1024 lds
    buffer_load_dwordx4 v102, s[8:11], s40 offen offset:2048 lds
    buffer_load_dwordx4 v103, s[8:11], s40 offen offset:3072 lds
    s_waitcnt vmcnt(4)
    s_barrier
    s_mov_b32 m0, s43
    s_add_u32 s42, s42, 16384
    buffer_load_dwordx4 v104, s[12:15], s41 offen offset:0 lds
    buffer_load_dwordx4 v105, s[12:15], s41 offen offset:1024 lds
    buffer_load_dwordx4 v106, s[12:15], s41 offen offset:2048 lds
    s_mov_b32 m0, s47
    s_add_u32 s43, s43, 24576
    buffer_load_dwordx4 v107, s[12:15], s41 offen offset:0 lds
    buffer_load_dwordx4 v108, s[12:15], s41 offen offset:1024 lds
    buffer_load_dwordx4 v109, s[12:15], s41 offen offset:2048 lds
    s_add_u32 s40, s40, 128
    s_add_u32 s41, s41, 393216
    s_cmp_eq_u32 s40, 2048
    s_cselect_b32 s40, 0, s40
    s_cselect_b32 s41, 0, s41
    s_cmp_eq_u32 s42, s46
    s_cselect_b32 s42, s44, s42
    s_cselect_b32 s43, s45, s43
    s_mov_b32 m0, s42
    s_add_u32 s47, s43, 3072
    buffer_load_dwordx4 v100, s[8:11], s40 offen lds
    buffer_load_dwordx4 v101, s[8:11], s40 offen offset:1024 lds
    buffer_load_dwordx4 v102, s[8:11], s40 offen offset:2048 lds
    buffer_load_dwordx4 v103, s[8:11], s40 offen offset:3072 lds
    s_mov_b32 m0, s43
    s_add_u32 s42, s42, 16384
    buffer_load_dwordx4 v104, s[12:15], s41 offen offset:0 lds
    buffer_load_dwordx4 v105, s[12:15], s41 offen offset:1024 lds
    buffer_load_dwordx4 v106, s[12:15], s41 offen offset:2048 lds
    s_mov_b32 m0, s47
    s_add_u32 s43, s43, 24576
    buffer_load_dwordx4 v107, s[12:15], s41 offen offset:0 lds
    buffer_load_dwordx4 v108, s[12:15], s41 offen offset:1024 lds
    buffer_load_dwordx4 v109, s[12:15], s41 offen offset:2048 lds
    s_add_u32 s40, s40, 128
    s_add_u32 s41, s41, 393216
    s_cmp_eq_u32 s40, 2048
    s_cselect_b32 s40, 0, s40
    s_cselect_b32 s41, 0, s41
    s_cmp_eq_u32 s42, s46
    s_cselect_b32 s42, s44, s42
    s_cselect_b32 s43, s45, s43
    s_waitcnt vmcnt(10)
    s_barrier
    s_mov_b32 m0, s42
    s_add_u32 s47, s43, 3072
    buffer_load_dwordx4 v100, s[8:11], s40 offen lds
    buffer_load_dwordx4 v101, s[8:11], s40 offen offset:1024 lds
    buffer_load_dwordx4 v102, s[8:11], s40 offen offset:2048 lds
    buffer_load_dwordx4 v103, s[8:11], s40 offen offset:3072 lds
    s_mov_b32 m0, s43
    s_add_u32 s42, s42, 16384
    buffer_load_dwordx4 v104, s[12:15], s41 offen offset:0 lds
    buffer_load_dwordx4 v105, s[12:15], s41 offen offset:1024 lds
    buffer_load_dwordx4 v106, s[12:15], s41 offen offset:2048 lds
    s_mov_b32 m0, s47
    s_add_u32 s43, s43, 24576
    buffer_load_dwordx4 v107, s[12:15], s41 offen offset:0 lds
    buffer_load_dwordx4 v108, s[12:15], s41 offen offset:1024 lds
    buffer_load_dwordx4 v109, s[12:15], s41 offen offset:2048 lds
    s_add_u32 s40, s40, 128
    s_add_u32 s41, s41, 393216
    s_cmp_eq_u32 s40, 2048
    s_cselect_b32 s40, 0, s40
    s_cselect_b32 s41, 0, s41
    s_cmp_eq_u32 s42, s46
    s_cselect_b32 s42, s44, s42
    s_cselect_b32 s43, s45, s43
    s_mov_b32 m0, s42
    s_add_u32 s47, s43, 3072
    buffer_load_dwordx4 v100, s[8:11], s40 offen lds
    buffer_load_dwordx4 v101, s[8:11], s40 offen offset:1024 lds
    buffer_load_dwordx4 v102, s[8:11], s40 offen offset:2048 lds
    buffer_load_dwordx4 v103, s[8:11], s40 offen offset:3072 lds
    s_mov_b32 m0, s43
    s_add_u32 s42, s42, 16384
    buffer_load_dwordx4 v104, s[12:15], s41 offen offset:0 lds
    buffer_load_dwordx4 v105, s[12:15], s41 offen offset:1024 lds
    buffer_load_dwordx4 v106, s[12:15], s41 offen offset:2048 lds
    s_mov_b32 m0, s47
    s_add_u32 s43, s43, 24576
    buffer_load_dwordx4 v107, s[12:15], s41 offen offset:0 lds
    buffer_load_dwordx4 v108, s[12:15], s41 offen offset:1024 lds
    buffer_load_dwordx4 v109, s[12:15], s41 offen offset:2048 lds
    s_add_u32 s40, s40, 128
    s_add_u32 s41, s41, 393216
    s_cmp_eq_u32 s40, 2048
    s_cselect_b32 s40, 0, s40
    s_cselect_b32 s41, 0, s41
    s_cmp_eq_u32 s42, s46
    s_cselect_b32 s42, s44, s42
    s_cselect_b32 s43, s45, s43
    s_waitcnt vmcnt(20)
    s_barrier
    s_cmp_eq_u32 s50, 0
    s_cselect_b32 s60, 1, 0
    s_mov_b32 s27, 2
K1_PLOOP:
    s_mov_b32 m0, s42
    s_add_u32 s47, s43, 3072
    buffer_load_dwordx4 v100, s[8:11], s40 offen lds
    buffer_load_dwordx4 v101, s[8:11], s40 offen offset:1024 lds
    buffer_load_dwordx4 v102, s[8:11], s40 offen offset:2048 lds
    buffer_load_dwordx4 v103, s[8:11], s40 offen offset:3072 lds
    s_cmp_eq_u32 s60, 0
    s_cbranch_scc1 K1_SK0
    v_fma_f32 v176, s52, v16, v0
    v_fma_f32 v177, s52, v17, v1
    v_fma_f32 v178, s52, v18, v2
    v_fma_f32 v179, s52, v19, v3
    v_fma_f32 v180, s52, v20, v4
    v_fma_f32 v181, s52, v21, v5
    v_fma_f32 v182, s52, v22, v6
    v_fma_f32 v183, s52, v23, v7
    v_fma_f32 v184, s52, v24, v8
    v_fma_f32 v185, s52, v25, v9
    v_fma_f32 v186, s52, v26, v10
    v_fma_f32 v187, s52, v27, v11
    v_fma_f32 v188, s52, v28, v12
    v_fma_f32 v189, s52, v29, v13
    v_fma_f32 v190, s52, v30, v14
    v_fma_f32 v191, s52, v31, v15
    v_cvt_pk_bf16_f32 v32, v176, v177
    v_cvt_pk_bf16_f32 v33, v178, v179
    v_cvt_pk_bf16_f32 v34, v180, v181
    v_cvt_pk_bf16_f32 v35, v182, v183
    v_cvt_pk_bf16_f32 v36, v184, v185
    v_cvt_pk_bf16_f32 v37, v186, v187
    v_cvt_pk_bf16_f32 v38, v188, v189
    v_cvt_pk_bf16_f32 v39, v190, v191
    v_mfma_f32_32x32x16_bf16 v[144:159], v[32:35], v[40:43], 0
    v_mfma_f32_32x32x16_bf16 v[160:175], v[32:35], v[48:51], 0
    v_mfma_f32_32x32x16_bf16 v[144:159], v[36:39], v[44:47], v[144:159]
    v_mfma_f32_32x32x16_bf16 v[160:175], v[36:39], v[52:55], v[160:175]
K1_SK0:
    s_mov_b32 m0, s43
    s_add_u32 s42, s42, 16384
    buffer_load_dwordx4 v104, s[12:15], s41 offen offset:0 lds
    buffer_load_dwordx4 v105, s[12:15], s41 offen offset:1024 lds
    buffer_load_dwordx4 v106, s[12:15], s41 offen offset:2048 lds
    s_cmp_eq_u32 s60, 0
    s_cbranch_scc1 K1_SK1
    v_mov_b32 v98, 0
    v_dot2c_f32_bf16 v98, v224, v240
    v_dot2c_f32_bf16 v98, v225, v241
    v_dot2c_f32_bf16 v98, v226, v242
    v_dot2c_f32_bf16 v98, v227, v243
    v_dot2c_f32_bf16 v98, v228, v244
    v_dot2c_f32_bf16 v98, v229, v245
    v_dot2c_f32_bf16 v98, v230, v246
    v_dot2c_f32_bf16 v98, v231, v247
    v_dot2c_f32_bf16 v98, v232, v248
    v_dot2c_f32_bf16 v98, v233, v249
    v_dot2c_f32_bf16 v98, v234, v250
    v_dot2c_f32_bf16 v98, v235, v251
    v_dot2c_f32_bf16 v98, v236, v252
    v_dot2c_f32_bf16 v98, v237, v253
    v_dot2c_f32_bf16 v98, v238, v254
    v_dot2c_f32_bf16 v98, v239, v255
    s_nop 2
    v_add_f32_dpp v98, v98, v98 row_shr:1 row_mask:0xf bank_mask:0xf bound_ctrl:0
    s_nop 1
    v_add_f32_dpp v98, v98, v98 row_shr:2 row_mask:0xf bank_mask:0xf bound_ctrl:0
    s_nop 1
    v_add_f32_dpp v98, v98, v98 row_shr:4 row_mask:0xf bank_mask:0xf bound_ctrl:0
    s_nop 1
    v_add_f32_dpp v98, v98, v98 row_shr:8 row_mask:0xf bank_mask:0xf bound_ctrl:0
    s_nop 1
    v_add_f32_dpp v98, v98, v98 row_bcast:15 row_mask:0xa bank_mask:0xf
K1_SK1:
    s_mov_b32 m0, s47
    s_add_u32 s43, s43, 24576
    buffer_load_dwordx4 v107, s[12:15], s41 offen offset:0 lds
    buffer_load_dwordx4 v108, s[12:15], s41 offen offset:1024 lds
    buffer_load_dwordx4 v109, s[12:15], s41 offen offset:2048 lds
    s_add_u32 s40, s40, 128
    s_add_u32 s41, s41, 393216
    s_cmp_eq_u32 s40, 2048
    s_cselect_b32 s40, 0, s40
    s_cselect_b32 s41, 0, s41
    s_cmp_eq_u32 s42, s46
    s_cselect_b32 s42, s44, s42
    s_cselect_b32 s43, s45, s43
    s_cmp_eq_u32 s60, 0
    s_cbranch_scc1 K1_SK2
    v_cvt_pk_bf16_f32 v98, v98, v98
    v_and_b32 v98, 0xffff0000, v98
    v_mul_f32 v98, 0xbfb8aa3b, v98
    v_exp_f32 v98, v98
    v_mov_b32 v92, s50
    v_add_f32 v98, 1.0, v98
    v_rcp_f32 v98, v98
    v_mov_b32 v91, s51
    v_cvt_pk_bf16_f32 v98, v98, v98
    v_and_b32 v192, 0xffff0000, v98
    v_sub_f32 v98, 1.0, v192
    v_cvt_pk_bf16_f32 v98, v98, v98
    v_and_b32 v193, 0xffff0000, v98
    v_cmp_lt_u32 vcc, 31, v99
    s_mov_b32 s58, 15794176
    s_mov_b32 exec_lo, 0x80000000
    s_mov_b32 exec_hi, 0x80000000
    v_cndmask_b32 v98, v92, v91, vcc
    v_lshlrev_b32 v98, 3, v98
    buffer_store_dwordx2 v[192:193], v98, s[16:19], s58 offen
    s_mov_b64 exec, -1
K1_SK2:
    s_waitcnt vmcnt(20)
    s_barrier
    s_mov_b32 m0, s42
    s_add_u32 s47, s43, 3072
    buffer_load_dwordx4 v100, s[8:11], s40 offen lds
    buffer_load_dwordx4 v101, s[8:11], s40 offen offset:1024 lds
    buffer_load_dwordx4 v102, s[8:11], s40 offen offset:2048 lds
    buffer_load_dwordx4 v103, s[8:11], s40 offen offset:3072 lds
    s_cmp_eq_u32 s60, 0
    s_cbranch_scc1 K1_SK3
    v_sub_f32 v98, v144, v145
    v_add_f32 v98, v98, v146
    v_sub_f32 v98, v98, v147
    v_add_f32 v98, v98, v148
    v_sub_f32 v98, v98, v149
    v_add_f32 v98, v98, v150
    v_sub_f32 v98, v98, v151
    v_add_f32 v98, v98, v152
    v_sub_f32 v98, v98, v153
    v_add_f32 v98, v98, v154
    v_sub_f32 v98, v98, v155
    v_add_f32 v98, v98, v156
    v_sub_f32 v98, v98, v157
    v_add_f32 v98, v98, v158
    v_sub_f32 v98, v98, v159
    s_nop 0
    v_readlane_b32 s59, v98, 32
    v_mov_b32 v92, 0
    s_nop 0
    v_add_f32 v98, s59, v98
    v_cvt_pk_bf16_f32 v110, v98, v92
K1_SK3:
    s_mov_b32 m0, s43
    s_add_u32 s42, s42, 16384
    buffer_load_dwordx4 v104, s[12:15], s41 offen offset:0 lds
    buffer_load_dwordx4 v105, s[12:15], s41 offen offset:1024 lds
    buffer_load_dwordx4 v106, s[12:15], s41 offen offset:2048 lds
    s_cmp_eq_u32 s60, 0
    s_cbranch_scc1 K1_SK4
    v_mul_f32 v176, v144, v112
    v_mul_f32 v177, v160, v112
    v_fmac_f32 v176, v160, v128
    v_fma_f32 v177, -v144, v128, v177
    v_mul_f32 v178, v145, v113
    v_mul_f32 v179, v161, v113
    v_fmac_f32 v178, v161, v129
    v_fma_f32 v179, -v145, v129, v179
    v_cvt_pk_bf16_f32 v72, v176, v178
    v_cvt_pk_bf16_f32 v80, v177, v179
    v_mul_f32 v180, v146, v114
    v_mul_f32 v181, v162, v114
    v_fmac_f32 v180, v162, v130
    v_fma_f32 v181, -v146, v130, v181
    v_mul_f32 v182, v147, v115
    v_mul_f32 v183, v163, v115
    v_fmac_f32 v182, v163, v131
    v_fma_f32 v183, -v147, v131, v183
    v_cvt_pk_bf16_f32 v73, v180, v182
    v_cvt_pk_bf16_f32 v81, v181, v183
K1_SK4:
    s_mov_b32 m0, s47
    s_add_u32 s43, s43, 24576
    buffer_load_dwordx4 v107, s[12:15], s41 offen offset:0 lds
    buffer_load_dwordx4 v108, s[12:15], s41 offen offset:1024 lds
    buffer_load_dwordx4 v109, s[12:15], s41 offen offset:2048 lds
    s_add_u32 s40, s40, 128
    s_add_u32 s41, s41, 393216
    s_cmp_eq_u32 s40, 2048
    s_cselect_b32 s40, 0, s40
    s_cselect_b32 s41, 0, s41
    s_cmp_eq_u32 s42, s46
    s_cselect_b32 s42, s44, s42
    s_cselect_b32 s43, s45, s43
    s_cmp_eq_u32 s60, 0
    s_cbranch_scc1 K1_SK5
    v_mul_f32 v176, v148, v116
    v_mul_f32 v177, v164, v116
    v_fmac_f32 v176, v164, v132
    v_fma_f32 v177, -v148, v132, v177
    v_mul_f32 v178, v149, v117
    v_mul_f32 v179, v165, v117
    v_fmac_f32 v178, v165, v133
    v_fma_f32 v179, -v149, v133, v179
    v_cvt_pk_bf16_f32 v74, v176, v178
    v_cvt_pk_bf16_f32 v82, v177, v179
    v_mul_f32 v180, v150, v118
    v_mul_f32 v181, v166, v118
    v_fmac_f32 v180, v166, v134
    v_fma_f32 v181, -v150, v134, v181
    v_mul_f32 v182, v151, v119
    v_mul_f32 v183, v167, v119
    v_fmac_f32 v182, v167, v135
    v_fma_f32 v183, -v151, v135, v183
    v_cvt_pk_bf16_f32 v75, v180, v182
    v_cvt_pk_bf16_f32 v83, v181, v183
K1_SK5:
    s_waitcnt vmcnt(20)
    s_barrier
    s_mov_b32 m0, s42
    s_add_u32 s47, s43, 3072
    buffer_load_dwordx4 v100, s[8:11], s40 offen lds
    buffer_load_dwordx4 v101, s[8:11], s40 offen offset:1024 lds
    buffer_load_dwordx4 v102, s[8:11], s40 offen offset:2048 lds
    buffer_load_dwordx4 v103, s[8:11], s40 offen offset:3072 lds
    s_cmp_eq_u32 s60, 0
    s_cbranch_scc1 K1_SK6
    v_mul_f32 v176, v152, v120
    v_mul_f32 v177, v168, v120
    v_fmac_f32 v176, v168, v136
    v_fma_f32 v177, -v152, v136, v177
    v_mul_f32 v178, v153, v121
    v_mul_f32 v179, v169, v121
    v_fmac_f32 v178, v169, v137
    v_fma_f32 v179, -v153, v137, v179
    v_cvt_pk_bf16_f32 v76, v176, v178
    v_cvt_pk_bf16_f32 v84, v177, v179
    v_mul_f32 v180, v154, v122
    v_mul_f32 v181, v170, v122
    v_fmac_f32 v180, v170, v138
    v_fma_f32 v181, -v154, v138, v181
    v_mul_f32 v182, v155, v123
    v_mul_f32 v183, v171, v123
    v_fmac_f32 v182, v171, v139
    v_fma_f32 v183, -v155, v139, v183
    v_cvt_pk_bf16_f32 v77, v180, v182
    v_cvt_pk_bf16_f32 v85, v181, v183
K1_SK6:
    s_mov_b32 m0, s43
    s_add_u32 s42, s42, 16384
    buffer_load_dwordx4 v104, s[12:15], s41 offen offset:0 lds
    buffer_load_dwordx4 v105, s[12:15], s41 offen offset:1024 lds
    buffer_load_dwordx4 v106, s[12:15], s41 offen offset:2048 lds
    s_cmp_eq_u32 s60, 0
    s_cbranch_scc1 K1_SK7
    v_mul_f32 v176, v156, v124
    v_mul_f32 v177, v172, v124
    v_fmac_f32 v176, v172, v140
    v_fma_f32 v177, -v156, v140, v177
    v_mul_f32 v178, v157, v125
    v_mul_f32 v179, v173, v125
    v_fmac_f32 v178, v173, v141
    v_fma_f32 v179, -v157, v141, v179
    v_cvt_pk_bf16_f32 v78, v176, v178
    v_cvt_pk_bf16_f32 v86, v177, v179
    v_mul_f32 v180, v158, v126
    v_mul_f32 v181, v174, v126
    v_fmac_f32 v180, v174, v142
    v_fma_f32 v181, -v158, v142, v181
    v_mul_f32 v182, v159, v127
    v_mul_f32 v183, v175, v127
    v_fmac_f32 v182, v175, v143
    v_fma_f32 v183, -v159, v143, v183
    v_cvt_pk_bf16_f32 v79, v180, v182
    v_cvt_pk_bf16_f32 v87, v181, v183
K1_SK7:
    s_mov_b32 m0, s47
    s_add_u32 s43, s43, 24576
    buffer_load_dwordx4 v107, s[12:15], s41 offen offset:0 lds
    buffer_load_dwordx4 v108, s[12:15], s41 offen offset:1024 lds
    buffer_load_dwordx4 v109, s[12:15], s41 offen offset:2048 lds
    s_add_u32 s40, s40, 128
    s_add_u32 s41, s41, 393216
    s_cmp_eq_u32 s40, 2048
    s_cselect_b32 s40, 0, s40
    s_cselect_b32 s41, 0, s41
    s_cmp_eq_u32 s42, s46
    s_cselect_b32 s42, s44, s42
    s_cselect_b32 s43, s45, s43
    s_cmp_eq_u32 s60, 0
    s_cbranch_scc1 K1_SK8
    v_mfma_f32_32x32x16_bf16 v[208:223], v[72:75], v[56:59], 0
    v_mfma_f32_32x32x16_bf16 v[208:223], v[80:83], v[64:67], v[208:223]
    v_mfma_f32_32x32x16_bf16 v[208:223], v[76:79], v[60:63], v[208:223]
    v_mfma_f32_32x32x16_bf16 v[208:223], v[84:87], v[68:71], v[208:223]
K1_SK8:
    s_waitcnt vmcnt(20)
    s_barrier
    s_mov_b32 m0, s42
    s_add_u32 s47, s43, 3072
    buffer_load_dwordx4 v100, s[8:11], s40 offen lds
    buffer_load_dwordx4 v101, s[8:11], s40 offen offset:1024 lds
    buffer_load_dwordx4 v102, s[8:11], s40 offen offset:2048 lds
    buffer_load_dwordx4 v103, s[8:11], s40 offen offset:3072 lds
    s_cmp_eq_u32 s60, 0
    s_cbranch_scc1 K1_SK9
    s_nop 7
    s_nop 3
    v_cvt_pk_bf16_f32 v176, v208, v209
    v_cvt_pk_bf16_f32 v177, v210, v211
    v_cvt_pk_bf16_f32 v178, v212, v213
    v_cvt_pk_bf16_f32 v179, v214, v215
    v_cvt_pk_bf16_f32 v180, v216, v217
    v_cvt_pk_bf16_f32 v181, v218, v219
    v_cvt_pk_bf16_f32 v182, v220, v221
    v_cvt_pk_bf16_f32 v183, v222, v223
    s_cmp_lg_u32 s50, 0
    s_cbranch_scc1 K1_NOROW
    s_mov_b32 exec_lo, 0xffff
    s_mov_b32 exec_hi, 0xffff
    buffer_store_dwordx4 v[176:179], v97, s[16:19], s54 offen
    buffer_store_dwordx4 v[180:183], v97, s[16:19], s54 offen offset:32
    s_mov_b64 exec, 1
    buffer_store_short v110, v97, s[16:19], s54 offen offset:1024
    s_mov_b64 exec, -1
    v_mov_b32 v176, 0
    v_mov_b32 v177, 0
    v_mov_b32 v178, 0
    v_mov_b32 v179, 0
    v_mov_b32 v180, 0
    v_mov_b32 v181, 0
    v_mov_b32 v182, 0
    v_mov_b32 v183, 0
    v_mov_b32 v110, 0
K1_NOROW:
K1_SK9:
    s_mov_b32 m0, s43
    s_add_u32 s42, s42, 16384
    buffer_load_dwordx4 v104, s[12:15], s41 offen offset:0 lds
    buffer_load_dwordx4 v105, s[12:15], s41 offen offset:1024 lds
    buffer_load_dwordx4 v106, s[12:15], s41 offen offset:2048 lds
    s_mov_b32 m0, s47
    s_add_u32 s43, s43, 24576
    buffer_load_dwordx4 v107, s[12:15], s41 offen offset:0 lds
    buffer_load_dwordx4 v108, s[12:15], s41 offen offset:1024 lds
    buffer_load_dwordx4 v109, s[12:15], s41 offen offset:2048 lds
    s_add_u32 s40, s40, 128
    s_add_u32 s41, s41, 393216
    s_cmp_eq_u32 s40, 2048
    s_cselect_b32 s40, 0, s40
    s_cselect_b32 s41, 0, s41
    s_cmp_eq_u32 s42, s46
    s_cselect_b32 s42, s44, s42
    s_cselect_b32 s43, s45, s43
    s_waitcnt vmcnt(20)
    s_barrier
    s_mov_b32 s60, 1
    s_mov_b32 s52, 1.0
    s_mov_b32 s54, 15728640
    s_sub_u32 s27, s27, 1
    s_cmp_lg_u32 s27, 0
    s_cbranch_scc1 K1_PLOOP
    s_mov_b32 m0, s42
    s_add_u32 s47, s43, 3072
    buffer_load_dwordx4 v100, s[8:11], s40 offen lds
    v_and_b32 v98, 15, v88
    v_mul_u32_u24 v93, 528, v98
    buffer_load_dwordx4 v101, s[8:11], s40 offen offset:1024 lds
    v_lshl_add_u32 v93, v89, 7, v93
    v_lshrrev_b32 v98, 4, v88
    buffer_load_dwordx4 v102, s[8:11], s40 offen offset:2048 lds
    v_lshl_add_u32 v93, v98, 3, v93
    s_lshl_b32 s58, s24, 1
    buffer_load_dwordx4 v103, s[8:11], s40 offen offset:3072 lds
    v_add_u32 v93, s58, v93
    v_mul_u32_u24 v94, 528, v89
    s_mov_b32 m0, s43
    s_add_u32 s42, s42, 16384
    buffer_load_dwordx4 v104, s[12:15], s41 offen offset:0 lds
    v_lshl_add_u32 v94, v88, 4, v94
    s_mul_i32 s58, s24, 2112
    v_add_u32 v94, s58, v94
    buffer_load_dwordx4 v105, s[12:15], s41 offen offset:1024 lds
    v_mul_u32_u24 v97, 4224, v99
    s_mul_i32 s58, s24, 540672
    buffer_load_dwordx4 v106, s[12:15], s41 offen offset:2048 lds
    s_and_b32 s59, s2, 7
    s_lshl_b32 s59, s59, 9
    s_mov_b32 m0, s47
    s_add_u32 s43, s43, 24576
    buffer_load_dwordx4 v107, s[12:15], s41 offen offset:0 lds
    s_add_u32 s58, s58, s59
    s_lshr_b32 s59, s2, 3
    buffer_load_dwordx4 v108, s[12:15], s41 offen offset:1024 lds
    s_lshl_b32 s59, s59, 4
    s_add_u32 s58, s58, s59
    buffer_load_dwordx4 v109, s[12:15], s41 offen offset:2048 lds
    s_add_u32 s40, s40, 128
    s_add_u32 s41, s41, 393216
    s_cmp_eq_u32 s40, 2048
    s_cselect_b32 s40, 0, s40
    s_cselect_b32 s41, 0, s41
    s_cmp_eq_u32 s42, s46
    s_cselect_b32 s42, s44, s42
    s_cselect_b32 s43, s45, s43
    s_add_u32 s58, s58, 12582912
    s_add_u32 s59, s58, 270336
    s_add_u32 s57, s58, 540672
    s_waitcnt vmcnt(20)
    s_barrier
    ds_write_b16 v93, v176 offset:0
    ds_write_b16_d16_hi v93, v176 offset:16
    ds_write_b16 v93, v177 offset:32
    ds_write_b16_d16_hi v93, v177 offset:48
    ds_write_b16 v93, v178 offset:64
    ds_write_b16_d16_hi v93, v178 offset:80
    ds_write_b16 v93, v179 offset:96
    ds_write_b16_d16_hi v93, v179 offset:112
    ds_write_b16 v93, v180 offset:256
    ds_write_b16_d16_hi v93, v180 offset:272
    ds_write_b16 v93, v181 offset:288
    ds_write_b16_d16_hi v93, v181 offset:304
    ds_write_b16 v93, v182 offset:320
    ds_write_b16_d16_hi v93, v182 offset:336
    ds_write_b16 v93, v183 offset:352
    ds_write_b16_d16_hi v93, v183 offset:368
    s_mov_b64 exec, 1
    ds_write_b16 v93, v110 offset:8448
    ds_write_b16_d16_hi v93, v110 offset:8456
    s_mov_b64 exec, -1
    s_waitcnt vmcnt(10) lgkmcnt(0)
    s_barrier
    ds_read_b128 v[176:179], v94
    ds_read_b128 v[180:183], v94 offset:1056
    ds_read_b128 v[184:187], v94 offset:2112
    s_waitcnt vmcnt(0)
    s_barrier
    s_lshl_b32 s92, s2, 2
    s_add_u32 s92, s92, s24
    s_lshl_b32 s92, s92, 11
    v_lshlrev_b32 v100, 7, v99
    s_mov_b64 exec, 0xffff
    buffer_load_dword v101, v100, s[88:91], s92 offen
    s_mov_b64 exec, -1
    s_waitcnt lgkmcnt(0)
    buffer_store_dwordx4 v[176:179], v97, s[16:19], s58 offen
    buffer_store_dwordx4 v[180:183], v97, s[16:19], s59 offen
    s_cmp_lg_u32 s24, 3
    s_cbranch_scc1 K1_END
    s_mov_b64 exec, 1
    buffer_store_dwordx4 v[184:187], v97, s[16:19], s57 offen
K1_END:
    s_endpgm
.globl k2_kernel
.p2align 8
.type k2_kernel,@function
k2_kernel:
    s_cmp_ge_u32 s2, 256
    s_cbranch_scc1 K2_END
    s_load_dwordx2 s[8:9], s[0:1], 88
    s_load_dwordx2 s[12:13], s[0:1], 56
    s_load_dwordx2 s[16:17], s[0:1], 72
    v_lshrrev_b32 v1, 6, v0
    v_and_b32 v129, 63, v0
    s_mov_b32 s10, 27262976
    v_readfirstlane_b32 s3, v1
    s_mov_b32 s11, 0x20000
    s_mov_b32 s14, 0x200000
    s_mov_b32 s15, 0x20000
    s_mov_b32 s18, 0x400000
    s_mov_b32 s19, 0x20000
    v_lshlrev_b32 v130, 4, v129
    s_and_b32 s4, s2, 7
    s_lshl_b32 s4, s4, 2
    s_bfe_u32 s5, s2, 0x20003
    s_add_u32 s4, s4, s5
    s_lshr_b32 s5, s2, 5
    s_lshl_b32 s5, s5, 3
    s_add_u32 s5, s5, s3
    s_lshl_b32 s20, s4, 18
    s_add_u32 s20, s20, 4194304
    s_lshl_b32 s21, s3, 12
    s_add_u32 s22, s20, s21
    s_lshl_b32 s23, s4, 6
    s_add_u32 s23, s23, s5
    s_lshl_b32 s23, s23, 11
    s_lshl_b32 s24, s5, 16
    s_lshl_b32 s25, s4, 11
    s_add_u32 s24, s24, s25
    s_add_u32 s24, s24, 16777216
    s_lshr_b32 s26, s3, 1
    s_lshl_b32 s25, s2, 1
    s_add_u32 s26, s26, s25
    s_cmp_lt_u32 s3, 4
    s_cselect_b32 s27, 1, 0
    s_cmp_eq_u32 s26, 510
    s_cselect_b32 s27, 2, s27
    s_cmp_lt_u32 s3, 4
    s_cselect_b32 s27, s27, 0
    s_mov_b32 m0, s21
    s_waitcnt lgkmcnt(0)
    buffer_load_dwordx4 v130, s[8:11], s22 offen offset:0 lds
    buffer_load_dwordx4 v130, s[8:11], s22 offen offset:1024 lds
    buffer_load_dwordx4 v130, s[8:11], s22 offen offset:2048 lds
    buffer_load_dwordx4 v130, s[8:11], s22 offen offset:3072 lds
    buffer_load_dwordx4 v[112:115], v130, s[8:11], s23 offen
    buffer_load_dwordx4 v[116:119], v130, s[8:11], s23 offen offset:1024
    s_add_u32 s21, s21, 0x8000
    s_add_u32 s22, s22, 0x8000
    s_mov_b32 m0, s21
    s_cmp_eq_u32 s27, 0
    s_cbranch_scc1 K2_NOJOB1
    v_and_b32 v228, 31, v129
    v_lshrrev_b32 v229, 5, v129
    v_and_b32 v230, 3, v129
    v_bfe_u32 v232, v129, 3, 2
    v_lshl_or_b32 v230, v232, 2, v230
    v_bfe_u32 v232, v129, 2, 1
    v_lshl_or_b32 v230, v232, 4, v230
    s_and_b32 s28, s3, 1
    s_lshl_b32 s29, s28, 5
    v_or_b32 v231, s29, v230
    v_lshlrev_b32 v232, 4, v230
    v_lshl_or_b32 v232, v229, 9, v232
    s_mul_i32 s30, s26, 4224
    s_add_u32 s31, s30, 12582912
    buffer_load_dwordx4 v[140:143], v232, s[8:11], s31 offen offset:0
    buffer_load_dwordx4 v[144:147], v232, s[8:11], s31 offen offset:1024
    buffer_load_dwordx4 v[148:151], v232, s[8:11], s31 offen offset:2048
    buffer_load_dwordx4 v[152:155], v232, s[8:11], s31 offen offset:3072
    v_mov_b32 v32, 0
    v_and_b32 v236, 1, v129
    v_lshlrev_b32 v236, 11, v236
    v_lshl_or_b32 v236, v229, 30, v236
    s_lshl_b32 s31, s26, 1
    s_add_u32 s31, s31, 15728640
    buffer_load_short_d16_hi v32, v236, s[8:11], s31 offen
    s_cmp_eq_u32 s27, 1
    s_cbranch_scc1 K2_NOJOB1
    v_mov_b32 v72, 0
    s_mov_b32 s31, 15729664
    buffer_load_short_d16_hi v72, v236, s[8:11], s31 offen
    s_mov_b32 s31, 14745600
    buffer_load_dwordx4 v[96:99], v232, s[8:11], s31 offen offset:0
    buffer_load_dwordx4 v[100:103], v232, s[8:11], s31 offen offset:1024
    buffer_load_dwordx4 v[104:107], v232, s[8:11], s31 offen offset:2048
    buffer_load_dwordx4 v[108:111], v232, s[8:11], s31 offen offset:3072
K2_NOJOB1:
    v_mov_b32 v131, v130
    v_add_u32 v132, 0x8000, v130
    v_and_b32 v133, 4, v129
    v_cmp_eq_u32 vcc, 0, v133
    v_mov_b32 v133, 0x3f803f80
    v_mov_b32 v128, 0xdddddddd
    v_cndmask_b32 v124, 0, v133, vcc
    v_xor_b32 v126, v124, v133
    v_mov_b32 v125, v124
    v_mov_b32 v127, v126
    v_mov_b64 v[0:1], 0
    v_mov_b64 v[2:3], 0
    v_mov_b64 v[4:5], 0
    v_mov_b64 v[6:7], 0
    v_mov_b64 v[8:9], 0
    v_mov_b64 v[10:11], 0
    v_mov_b64 v[12:13], 0
    v_mov_b64 v[14:15], 0
    v_mov_b64 v[120:121], 0
    v_mov_b64 v[122:123], 0
    s_mov_b32 s48, s2
    s_and_b32 s41, s48, 7
    s_lshl_b32 s41, s41, 1
    s_bfe_u32 s42, s48, 0x10003
    s_add_u32 s41, s41, s42
    s_lshr_b32 s42, s48, 4
    s_and_b32 s43, s3, 3
    s_lshr_b32 s44, s3, 2
    s_lshl_b32 s41, s41, 2
    s_add_u32 s41, s41, s43
    s_lshl_b32 s40, s3, 16
    s_lshl_b32 s43, s42, 7
    s_add_u32 s40, s40, s43
    s_and_b32 s36, s48, 3
    s_lshl_b32 s43, s36, 19
    s_add_u32 s40, s40, s43
    s_lshl_b32 s36, s36, 1
    s_lshl_b32 s60, s41, 16
    s_lshl_b32 s61, s44, 15
    s_add_u32 s60, s60, s61
    s_add_u32 s60, s60, 16777216
    s_add_u32 s43, s42, 0
    s_and_b32 s43, s43, 3
    s_lshl_b32 s61, s43, 13
    s_add_u32 s54, s60, s61
    s_lshl_b32 s61, s44, 2
    s_add_u32 s43, s43, s61
    s_sub_u32 s43, s43, s36
    s_and_b32 s43, s43, 7
    s_cmp_ge_u32 s43, 4
    s_cselect_b32 s61, -4, 6
    s_add_u32 s43, s43, s61
    s_lshl_b32 s50, s43, 14
    s_add_u32 s43, s42, 1
    s_and_b32 s43, s43, 3
    s_lshl_b32 s61, s43, 13
    s_add_u32 s55, s60, s61
    s_lshl_b32 s61, s44, 2
    s_add_u32 s43, s43, s61
    s_sub_u32 s43, s43, s36
    s_and_b32 s43, s43, 7
    s_cmp_ge_u32 s43, 4
    s_cselect_b32 s61, -4, 6
    s_add_u32 s43, s43, s61
    s_lshl_b32 s51, s43, 14
    s_add_u32 s43, s42, 2
    s_and_b32 s43, s43, 3
    s_lshl_b32 s61, s43, 13
    s_add_u32 s56, s60, s61
    s_lshl_b32 s61, s44, 2
    s_add_u32 s43, s43, s61
    s_sub_u32 s43, s43, s36
    s_and_b32 s43, s43, 7
    s_cmp_ge_u32 s43, 4
    s_cselect_b32 s61, -4, 6
    s_add_u32 s43, s43, s61
    s_lshl_b32 s52, s43, 14
    s_add_u32 s43, s42, 3
    s_and_b32 s43, s43, 3
    s_lshl_b32 s61, s43, 13
    s_add_u32 s57, s60, s61
    s_lshl_b32 s61, s44, 2
    s_add_u32 s43, s43, s61
    s_sub_u32 s43, s43, s36
    s_and_b32 s43, s43, 7
    s_cmp_ge_u32 s43, 4
    s_cselect_b32 s61, -4, 6
    s_add_u32 s43, s43, s61
    s_lshl_b32 s53, s43, 14
    v_lshrrev_b32 v133, 3, v129
    v_and_b32 v134, 7, v129
    v_bfe_u32 v135, v129, 4, 1
    v_lshlrev_b32 v135, 2, v135
    v_xor_b32 v134, v134, v135
    v_lshlrev_b32 v134, 4, v134
    v_lshl_or_b32 v246, v133, 11, v134
    v_lshrrev_b32 v133, 5, v129
    v_bfe_u32 v134, v129, 2, 2
    v_lshl_or_b32 v134, v133, 2, v134
    v_lshlrev_b32 v247, 7, v134
    v_bfe_u32 v134, v129, 3, 1
    v_xor_b32 v134, s44, v134
    v_lshl_or_b32 v247, v134, 6, v247
    v_and_b32 v134, 1, v129
    v_lshl_or_b32 v247, v134, 5, v247
    v_mul_u32_u24 v251, 0x202, v134
    v_lshlrev_b32 v251, 16, v251
    v_add_u32 v251, 0x01000c0c, v251
    v_bfe_u32 v134, v129, 4, 1
    v_lshl_or_b32 v247, v134, 4, v247
    v_bfe_u32 v134, v129, 1, 1
    v_lshl_or_b32 v247, v134, 3, v247
    v_add_u32 v252, 4096, v130
    s_lshl_b32 s61, s3, 12
    s_add_u32 s61, s61, 0x10000
    v_add_u32 v139, s61, v130
    v_and_b32 v134, 31, v129
    s_lshl_b32 s61, s41, 5
    v_add_u32 v134, s61, v134
    s_lshl_b32 s60, s42, 6
    s_lshl_b32 s61, s44, 5
    s_add_u32 s60, s60, s61
    v_lshlrev_b32 v135, 4, v133
    v_add_u32 v135, s60, v135
    v_lshlrev_b32 v249, 11, v134
    v_lshl_or_b32 v249, v135, 1, v249
    v_lshlrev_b32 v250, 3, v134
    v_sub_u32 v136, 2048, v134
    v_sub_u32 v137, 1024, v135
    s_cmp_lt_u32 s42, 8
    s_cselect_b64 vcc, 0, -1
    s_movk_i32 s58, -4224
    s_cselect_b32 s58, 4224, s58
    v_cndmask_b32 v134, v134, v136, vcc
    v_cndmask_b32 v135, v135, v137, vcc
    v_mul_u32_u24 v248, 4224, v135
    v_and_b32 v134, -2, v134
    v_lshl_add_u32 v248, v134, 1, v248
    s_mov_b32 s49, 15859712
    s_mov_b32 s46, 0
    s_mov_b64 s[88:89], s[8:9]
    s_mov_b64 s[90:91], s[10:11]
    s_mov_b32 s35, 0
    s_mov_b32 s38, 0x8000
    s_mov_b32 s39, -1
    s_mov_b32 s32, 0x8000
    s_cmp_eq_u32 s27, 0
    s_cbranch_scc1 K2_NOJOB2
    v_cvt_f32_u32 v239, v231
    v_cvt_f32_u32 v238, v229
    v_mul_f32 v232, 0x3c800000, v239
    v_mul_f32 v233, 4.0, v238
    v_mul_f32 v233, v232, v233
    v_mul_f32 v240, 0x40a00000, v232
    v_cos_f32 v242, v233
    v_sin_f32 v244, v233
    v_add_f32 v233, v233, v232
    v_cos_f32 v243, v233
    v_sin_f32 v245, v233
    v_add_f32 v233, v233, v232
    v_cvt_pk_bf16_f32 v158, v242, v243
    v_cvt_pk_bf16_f32 v160, v244, v245
    v_xor_b32 v156, 0x80008000, v160
    v_cos_f32 v242, v233
    v_sin_f32 v244, v233
    v_add_f32 v233, v233, v232
    v_cos_f32 v243, v233
    v_sin_f32 v245, v233
    v_add_f32 v233, v233, v240
    v_cvt_pk_bf16_f32 v159, v242, v243
    v_cvt_pk_bf16_f32 v161, v244, v245
    v_xor_b32 v157, 0x80008000, v161
    v_cos_f32 v242, v233
    v_sin_f32 v244, v233
    v_add_f32 v233, v233, v232
    v_cos_f32 v243, v233
    v_sin_f32 v245, v233
    v_add_f32 v233, v233, v232
    v_cvt_pk_bf16_f32 v164, v242, v243
    v_cvt_pk_bf16_f32 v166, v244, v245
    v_xor_b32 v162, 0x80008000, v166
    v_cos_f32 v242, v233
    v_sin_f32 v244, v233
    v_add_f32 v233, v233, v232
    v_cos_f32 v243, v233
    v_sin_f32 v245, v233
    v_add_f32 v233, v233, v240
    v_cvt_pk_bf16_f32 v165, v242, v243
    v_cvt_pk_bf16_f32 v167, v244, v245
    v_xor_b32 v163, 0x80008000, v167
    v_cos_f32 v242, v233
    v_sin_f32 v244, v233
    v_add_f32 v233, v233, v232
    v_cos_f32 v243, v233
    v_sin_f32 v245, v233
    v_add_f32 v233, v233, v232
    v_cvt_pk_bf16_f32 v170, v242, v243
    v_cvt_pk_bf16_f32 v172, v244, v245
    v_xor_b32 v168, 0x80008000, v172
    v_cos_f32 v242, v233
    v_sin_f32 v244, v233
    v_add_f32 v233, v233, v232
    v_cos_f32 v243, v233
    v_sin_f32 v245, v233
    v_add_f32 v233, v233, v240
    v_cvt_pk_bf16_f32 v171, v242, v243
    v_cvt_pk_bf16_f32 v173, v244, v245
    v_xor_b32 v169, 0x80008000, v173
    v_cos_f32 v242, v233
    v_sin_f32 v244, v233
    v_add_f32 v233, v233, v232
    v_cos_f32 v243, v233
    v_sin_f32 v245, v233
    v_add_f32 v233, v233, v232
    v_cvt_pk_bf16_f32 v176, v242, v243
    v_cvt_pk_bf16_f32 v178, v244, v245
    v_xor_b32 v174, 0x80008000, v178
    v_cos_f32 v242, v233
    v_sin_f32 v244, v233
    v_add_f32 v233, v233, v232
    v_cos_f32 v243, v233
    v_sin_f32 v245, v233
    v_cvt_pk_bf16_f32 v177, v242, v243
    v_cvt_pk_bf16_f32 v179, v244, v245
    v_xor_b32 v175, 0x80008000, v179
    buffer_load_dwordx4 v130, s[8:11], s22 offen offset:0 lds
    buffer_load_dwordx4 v130, s[8:11], s22 offen offset:1024 lds
    buffer_load_dwordx4 v130, s[8:11], s22 offen offset:2048 lds
    buffer_load_dwordx4 v130, s[8:11], s22 offen offset:3072 lds
    s_add_u32 s21, s21, 0x8000
    s_add_u32 s22, s22, 0x8000
    s_mov_b32 m0, s21
    v_mul_f32 v238, 0x41800000, v238
    v_mul_f32 v232, 0x3a000000, v239
    v_mul_f32 v233, v232, v238
    v_mov_b32 v33, 0
    v_mov_b64 v[34:35], 0
    v_mov_b64 v[36:37], 0
    v_mov_b64 v[38:39], 0
    v_mov_b64 v[40:41], 0
    v_mov_b64 v[42:43], 0
    v_mov_b64 v[44:45], 0
    v_mov_b64 v[46:47], 0
    v_cos_f32 v196, v233
    v_sin_f32 v212, v233
    v_add_f32 v233, v233, v232
    v_cos_f32 v197, v233
    v_sin_f32 v213, v233
    v_add_f32 v233, v233, v232
    v_cos_f32 v198, v233
    v_sin_f32 v214, v233
    v_add_f32 v233, v233, v232
    v_cos_f32 v199, v233
    v_sin_f32 v215, v233
    v_add_f32 v233, v233, v232
    v_cos_f32 v200, v233
    v_sin_f32 v216, v233
    v_add_f32 v233, v233, v232
    v_cos_f32 v201, v233
    v_sin_f32 v217, v233
    v_add_f32 v233, v233, v232
    v_cos_f32 v202, v233
    v_sin_f32 v218, v233
    v_add_f32 v233, v233, v232
    v_cos_f32 v203, v233
    v_sin_f32 v219, v233
    v_add_f32 v233, v233, v232
    v_cos_f32 v204, v233
    v_sin_f32 v220, v233
    v_add_f32 v233, v233, v232
    v_cos_f32 v205, v233
    v_sin_f32 v221, v233
    v_add_f32 v233, v233, v232
    v_cos_f32 v206, v233
    v_sin_f32 v222, v233
    v_add_f32 v233, v233, v232
    v_cos_f32 v207, v233
    v_sin_f32 v223, v233
    v_add_f32 v233, v233, v232
    v_cos_f32 v208, v233
    v_sin_f32 v224, v233
    v_add_f32 v233, v233, v232
    v_cos_f32 v209, v233
    v_sin_f32 v225, v233
    v_add_f32 v233, v233, v232
    v_cos_f32 v210, v233
    v_sin_f32 v226, v233
    v_add_f32 v233, v233, v232
    v_cos_f32 v211, v233
    v_sin_f32 v227, v233
    buffer_load_dwordx4 v130, s[8:11], s22 offen offset:0 lds
    buffer_load_dwordx4 v130, s[8:11], s22 offen offset:1024 lds
    buffer_load_dwordx4 v130, s[8:11], s22 offen offset:2048 lds
    buffer_load_dwordx4 v130, s[8:11], s22 offen offset:3072 lds
    s_add_u32 s21, s21, 0x8000
    s_add_u32 s22, s22, 0x8000
    s_mov_b32 m0, s21
    v_cvt_f32_u32 v232, v228
    v_mul_f32 v232, 0x3d000000, v232
    v_mul_f32 v233, v232, v238
    v_cos_f32 v242, v233
    v_sin_f32 v244, v233
    v_add_f32 v233, v233, v232
    v_cos_f32 v243, v233
    v_sin_f32 v245, v233
    v_add_f32 v233, v233, v232
    v_cvt_pk_bf16_f32 v180, v242, v243
    v_cvt_pk_bf16_f32 v188, v244, v245
    v_cos_f32 v242, v233
    v_sin_f32 v244, v233
    v_add_f32 v233, v233, v232
    v_cos_f32 v243, v233
    v_sin_f32 v245, v233
    v_add_f32 v233, v233, v232
    v_cvt_pk_bf16_f32 v181, v242, v243
    v_cvt_pk_bf16_f32 v189, v244, v245
    v_cos_f32 v242, v233
    v_sin_f32 v244, v233
    v_add_f32 v233, v233, v232
    v_cos_f32 v243, v233
    v_sin_f32 v245, v233
    v_add_f32 v233, v233, v232
    v_cvt_pk_bf16_f32 v182, v242, v243
    v_cvt_pk_bf16_f32 v190, v244, v245
    v_cos_f32 v242, v233
    v_sin_f32 v244, v233
    v_add_f32 v233, v233, v232
    v_cos_f32 v243, v233
    v_sin_f32 v245, v233
    v_add_f32 v233, v233, v232
    v_cvt_pk_bf16_f32 v183, v242, v243
    v_cvt_pk_bf16_f32 v191, v244, v245
    v_cos_f32 v242, v233
    v_sin_f32 v244, v233
    v_add_f32 v233, v233, v232
    v_cos_f32 v243, v233
    v_sin_f32 v245, v233
    v_add_f32 v233, v233, v232
    v_cvt_pk_bf16_f32 v184, v242, v243
    v_cvt_pk_bf16_f32 v192, v244, v245
    v_cos_f32 v242, v233
    v_sin_f32 v244, v233
    v_add_f32 v233, v233, v232
    v_cos_f32 v243, v233
    v_sin_f32 v245, v233
    v_add_f32 v233, v233, v232
    v_cvt_pk_bf16_f32 v185, v242, v243
    v_cvt_pk_bf16_f32 v193, v244, v245
    v_cos_f32 v242, v233
    v_sin_f32 v244, v233
    v_add_f32 v233, v233, v232
    v_cos_f32 v243, v233
    v_sin_f32 v245, v233
    v_add_f32 v233, v233, v232
    v_cvt_pk_bf16_f32 v186, v242, v243
    v_cvt_pk_bf16_f32 v194, v244, v245
    v_cos_f32 v242, v233
    v_sin_f32 v244, v233
    v_add_f32 v233, v233, v232
    v_cos_f32 v243, v233
    v_sin_f32 v245, v233
    v_cvt_pk_bf16_f32 v187, v242, v243
    v_cvt_pk_bf16_f32 v195, v244, v245
    v_lshlrev_b32 v234, 7, v228
    v_lshl_or_b32 v234, v229, 5, v234
    s_lshl_b32 s28, s28, 6
    s_add_u32 s30, s30, s28
    s_add_u32 s30, s30, 20971520
    buffer_load_dwordx4 v130, s[8:11], s22 offen offset:0 lds
    s_waitcnt vmcnt(16)
    s_barrier
    s_waitcnt vmcnt(9)
K2_JOBC:
    v_mfma_f32_32x32x16_bf16 v[32:47], v[140:143], v[158:161], v[32:47]
    v_mfma_f32_32x32x16_bf16 v[48:63], v[140:143], v[156:159], 0
    v_mfma_f32_32x32x16_bf16 v[32:47], v[144:147], v[164:167], v[32:47]
    v_mfma_f32_32x32x16_bf16 v[48:63], v[144:147], v[162:165], v[48:63]
    v_mfma_f32_32x32x16_bf16 v[32:47], v[148:151], v[170:173], v[32:47]
    v_mfma_f32_32x32x16_bf16 v[48:63], v[148:151], v[168:171], v[48:63]
    v_mfma_f32_32x32x16_bf16 v[32:47], v[152:155], v[176:179], v[32:47]
    v_mfma_f32_32x32x16_bf16 v[48:63], v[152:155], v[174:177], v[48:63]
    s_nop 10
    v_pk_mul_f32 v[238:239], v[32:33], v[196:197]
    v_pk_mul_f32 v[240:241], v[48:49], v[196:197]
    v_pk_fma_f32 v[238:239], v[48:49], v[212:213], v[238:239]
    v_pk_fma_f32 v[240:241], v[32:33], v[212:213], v[240:241] neg_lo:[1,0,0] neg_hi:[1,0,0]
    v_cvt_pk_bf16_f32 v140, v238, v239
    v_cvt_pk_bf16_f32 v148, v240, v241
    v_pk_mul_f32 v[242:243], v[34:35], v[198:199]
    v_pk_mul_f32 v[244:245], v[50:51], v[198:199]
    v_pk_fma_f32 v[242:243], v[50:51], v[214:215], v[242:243]
    v_pk_fma_f32 v[244:245], v[34:35], v[214:215], v[244:245] neg_lo:[1,0,0] neg_hi:[1,0,0]
    v_cvt_pk_bf16_f32 v141, v242, v243
    v_cvt_pk_bf16_f32 v149, v244, v245
    v_pk_mul_f32 v[238:239], v[36:37], v[200:201]
    v_pk_mul_f32 v[240:241], v[52:53], v[200:201]
    v_pk_fma_f32 v[238:239], v[52:53], v[216:217], v[238:239]
    v_pk_fma_f32 v[240:241], v[36:37], v[216:217], v[240:241] neg_lo:[1,0,0] neg_hi:[1,0,0]
    v_cvt_pk_bf16_f32 v142, v238, v239
    v_cvt_pk_bf16_f32 v150, v240, v241
    v_pk_mul_f32 v[242:243], v[38:39], v[202:203]
    v_pk_mul_f32 v[244:245], v[54:55], v[202:203]
    v_pk_fma_f32 v[242:243], v[54:55], v[218:219], v[242:243]
    v_pk_fma_f32 v[244:245], v[38:39], v[218:219], v[244:245] neg_lo:[1,0,0] neg_hi:[1,0,0]
    v_cvt_pk_bf16_f32 v143, v242, v243
    v_cvt_pk_bf16_f32 v151, v244, v245
    s_nop 0
    v_mfma_f32_32x32x16_bf16 v[80:95], v[140:143], v[180:183], 0
    v_mfma_f32_32x32x16_bf16 v[80:95], v[148:151], v[188:191], v[80:95]
    v_pk_mul_f32 v[238:239], v[40:41], v[204:205]
    v_pk_mul_f32 v[240:241], v[56:57], v[204:205]
    v_pk_fma_f32 v[238:239], v[56:57], v[220:221], v[238:239]
    v_pk_fma_f32 v[240:241], v[40:41], v[220:221], v[240:241] neg_lo:[1,0,0] neg_hi:[1,0,0]
    v_cvt_pk_bf16_f32 v144, v238, v239
    v_cvt_pk_bf16_f32 v152, v240, v241
    v_pk_mul_f32 v[242:243], v[42:43], v[206:207]
    v_pk_mul_f32 v[244:245], v[58:59], v[206:207]
    v_pk_fma_f32 v[242:243], v[58:59], v[222:223], v[242:243]
    v_pk_fma_f32 v[244:245], v[42:43], v[222:223], v[244:245] neg_lo:[1,0,0] neg_hi:[1,0,0]
    v_cvt_pk_bf16_f32 v145, v242, v243
    v_cvt_pk_bf16_f32 v153, v244, v245
    v_pk_mul_f32 v[238:239], v[44:45], v[208:209]
    v_pk_mul_f32 v[240:241], v[60:61], v[208:209]
    v_pk_fma_f32 v[238:239], v[60:61], v[224:225], v[238:239]
    v_pk_fma_f32 v[240:241], v[44:45], v[224:225], v[240:241] neg_lo:[1,0,0] neg_hi:[1,0,0]
    v_cvt_pk_bf16_f32 v146, v238, v239
    v_cvt_pk_bf16_f32 v154, v240, v241
    v_pk_mul_f32 v[242:243], v[46:47], v[210:211]
    v_pk_mul_f32 v[244:245], v[62:63], v[210:211]
    v_pk_fma_f32 v[242:243], v[62:63], v[226:227], v[242:243]
    v_pk_fma_f32 v[244:245], v[46:47], v[226:227], v[244:245] neg_lo:[1,0,0] neg_hi:[1,0,0]
    v_cvt_pk_bf16_f32 v147, v242, v243
    v_cvt_pk_bf16_f32 v155, v244, v245
    s_nop 0
    v_mfma_f32_32x32x16_bf16 v[80:95], v[144:147], v[184:187], v[80:95]
    v_mfma_f32_32x32x16_bf16 v[80:95], v[152:155], v[192:195], v[80:95]
    s_nop 11
    v_cvt_pk_bf16_f32 v64, v80, v81
    v_cvt_pk_bf16_f32 v65, v82, v83
    v_cvt_pk_bf16_f32 v66, v84, v85
    v_cvt_pk_bf16_f32 v67, v86, v87
    v_cvt_pk_bf16_f32 v68, v88, v89
    v_cvt_pk_bf16_f32 v69, v90, v91
    v_cvt_pk_bf16_f32 v70, v92, v93
    v_cvt_pk_bf16_f32 v71, v94, v95
    buffer_store_dwordx4 v[64:67], v234, s[8:11], s30 offen sc1
    buffer_store_dwordx4 v[68:71], v234, s[8:11], s30 offen offset:16 sc1
    s_add_u32 s30, s30, 4096
    s_cmp_lg_u32 s28, 0
    s_cbranch_scc1 K2_NOWRAP
    s_mov_b64 exec, 1
    buffer_store_dword v64, v234, s[8:11], s30 offen sc1
    s_mov_b64 exec, -1
K2_NOWRAP:
    s_cmp_eq_u32 s27, 1
    s_cbranch_scc1 K2_START
    s_mov_b32 s27, 1
    s_add_u32 s30, s28, 23134208
    v_mov_b32 v32, v72
    v_mov_b32 v33, 0
    v_mov_b64 v[34:35], 0
    v_mov_b64 v[36:37], 0
    v_mov_b64 v[38:39], 0
    v_mov_b64 v[40:41], 0
    v_mov_b64 v[42:43], 0
    v_mov_b64 v[44:45], 0
    v_mov_b64 v[46:47], 0
    v_mov_b64 v[140:141], v[96:97]
    v_mov_b64 v[142:143], v[98:99]
    v_mov_b64 v[144:145], v[100:101]
    v_mov_b64 v[146:147], v[102:103]
    v_mov_b64 v[148:149], v[104:105]
    v_mov_b64 v[150:151], v[106:107]
    v_mov_b64 v[152:153], v[108:109]
    v_mov_b64 v[154:155], v[110:111]
    s_nop 1
    s_branch K2_JOBC
K2_NOJOB2:
    buffer_load_dwordx4 v130, s[8:11], s22 offen offset:0 lds
    buffer_load_dwordx4 v130, s[8:11], s22 offen offset:1024 lds
    buffer_load_dwordx4 v130, s[8:11], s22 offen offset:2048 lds
    buffer_load_dwordx4 v130, s[8:11], s22 offen offset:3072 lds
    s_add_u32 s21, s21, 0x8000
    s_add_u32 s22, s22, 0x8000
    s_mov_b32 m0, s21
    s_nop 0
    buffer_load_dwordx4 v130, s[8:11], s22 offen offset:0 lds
    buffer_load_dwordx4 v130, s[8:11], s22 offen offset:1024 lds
    buffer_load_dwordx4 v130, s[8:11], s22 offen offset:2048 lds
    buffer_load_dwordx4 v130, s[8:11], s22 offen offset:3072 lds
    s_add_u32 s21, s21, 0x8000
    s_add_u32 s22, s22, 0x8000
    s_mov_b32 m0, s21
    s_nop 0
    buffer_load_dwordx4 v130, s[8:11], s22 offen offset:0 lds
    s_waitcnt vmcnt(9)
    s_barrier
K2_START:
    ds_read_b128 v[80:83], v131 offset:0
    ds_read_b128 v[84:87], v131 offset:1024
    ds_read_b128 v[88:91], v131 offset:4096
    ds_read_b128 v[92:95], v131 offset:5120
    ds_read_b128 v[96:99], v131 offset:2048
    ds_read_b128 v[100:103], v131 offset:3072
    v_mov_b64 v[56:57], 0
    v_mov_b64 v[58:59], 0
    v_mov_b64 v[60:61], 0
    v_mov_b64 v[62:63], 0
    v_mov_b64 v[108:109], 0
    v_mov_b64 v[110:111], 0
    v_mov_b32 v245, v130
    s_waitcnt lgkmcnt(4)
    v_mfma_f32_32x32x16_bf16 v[32:47], v[80:83], v[112:115], 0
    v_mfma_f32_32x32x16_bf16 v[32:47], v[84:87], v[116:119], v[32:47]
    s_nop 11
    v_max_f32 v133, v32, v33
    v_max3_f32 v133, v34, v35, v133
    v_max3_f32 v133, v36, v37, v133
    v_max3_f32 v133, v38, v39, v133
    v_max3_f32 v133, v40, v41, v133
    v_max3_f32 v133, v42, v43, v133
    v_max3_f32 v133, v44, v45, v133
    v_max3_f32 v133, v46, v47, v133
    v_mov_b32 v134, v133
    s_nop 1
    v_permlane32_swap_b32 v133, v134
    v_max_f32 v133, v133, v134
    v_sub_f32 v16, 0, v133
    v_sub_f32 v17, 0, v133
    v_mov_b64 v[18:19], v[16:17]
    v_mov_b64 v[20:21], v[16:17]
    v_mov_b64 v[22:23], v[16:17]
    v_mov_b64 v[24:25], v[16:17]
    v_mov_b64 v[26:27], v[16:17]
    v_mov_b64 v[28:29], v[16:17]
    v_mov_b64 v[30:31], v[16:17]
    s_nop 1
    v_mfma_f32_32x32x16_bf16 v[32:47], v[80:83], v[112:115], v[16:31]
    v_mfma_f32_32x32x16_bf16 v[32:47], v[84:87], v[116:119], v[32:47]
    s_mov_b32 s33, 0
    s_nop 7
    s_nop 2
.p2align 6
K2_LOOP:
    v_exp_f32 v32, v32
    s_waitcnt lgkmcnt(0)
    v_smfmac_f32_32x32x32_bf16 v[0:15], v[108:111], v[56:63], v128
    ds_read_b128 v[80:83], v131 offset:8192
    v_exp_f32 v33, v33
    ds_read_b128 v[84:87], v131 offset:9216
    v_exp_f32 v34, v34
    ds_read_b128 v[104:107], v131 offset:6144
    v_exp_f32 v35, v35
    v_smfmac_f32_16x16x64_bf16 v[120:123], v[124:127], v[56:63], v128
    ds_read_b128 v[108:111], v131 offset:7168
    v_exp_f32 v36, v36
    v_mfma_f32_32x32x16_bf16 v[48:63], v[88:91], v[112:115], v[16:31]
    v_exp_f32 v37, v37
    v_exp_f32 v38, v38
    v_exp_f32 v39, v39
    v_mfma_f32_32x32x16_bf16 v[48:63], v[92:95], v[116:119], v[48:63]
    buffer_load_dwordx4 v245, s[88:91], s22 offen offset:1024 lds
    s_add_u32 s22, s22, s35
    v_exp_f32 v40, v40
    v_exp_f32 v41, v41
    v_exp_f32 v42, v42
    v_smfmac_f32_32x32x32_bf16 v[0:15], v[96:99], v[32:39], v128
    v_exp_f32 v43, v43
    v_exp_f32 v44, v44
    v_exp_f32 v45, v45
    v_smfmac_f32_16x16x64_bf16 v[120:123], v[124:127], v[32:39], v128
    v_exp_f32 v46, v46
    v_exp_f32 v47, v47
    v_exp_f32 v48, v48
    s_waitcnt lgkmcnt(0)
    v_smfmac_f32_32x32x32_bf16 v[0:15], v[100:103], v[40:47], v128
    ds_read_b128 v[88:91], v131 offset:12288
    v_exp_f32 v49, v49
    ds_read_b128 v[92:95], v131 offset:13312
    v_exp_f32 v50, v50
    ds_read_b128 v[96:99], v131 offset:10240
    v_exp_f32 v51, v51
    v_smfmac_f32_16x16x64_bf16 v[120:123], v[124:127], v[40:47], v128
    ds_read_b128 v[100:103], v131 offset:11264
    v_exp_f32 v52, v52
    v_mfma_f32_32x32x16_bf16 v[32:47], v[80:83], v[112:115], v[16:31]
    v_exp_f32 v53, v53
    v_exp_f32 v54, v54
    v_exp_f32 v55, v55
    v_mfma_f32_32x32x16_bf16 v[32:47], v[84:87], v[116:119], v[32:47]
    v_exp_f32 v56, v56
    v_exp_f32 v57, v57
    v_exp_f32 v58, v58
    v_smfmac_f32_32x32x32_bf16 v[0:15], v[104:107], v[48:55], v128
    v_exp_f32 v59, v59
    v_exp_f32 v60, v60
    v_exp_f32 v61, v61
    v_smfmac_f32_16x16x64_bf16 v[120:123], v[124:127], v[48:55], v128
    v_exp_f32 v62, v62
    v_exp_f32 v63, v63
    s_nop 1
    v_exp_f32 v32, v32
    s_waitcnt lgkmcnt(0)
    v_smfmac_f32_32x32x32_bf16 v[0:15], v[108:111], v[56:63], v128
    ds_read_b128 v[80:83], v131 offset:16384
    v_exp_f32 v33, v33
    ds_read_b128 v[84:87], v131 offset:17408
    v_exp_f32 v34, v34
    ds_read_b128 v[104:107], v131 offset:14336
    v_exp_f32 v35, v35
    v_smfmac_f32_16x16x64_bf16 v[120:123], v[124:127], v[56:63], v128
    ds_read_b128 v[108:111], v131 offset:15360
    v_exp_f32 v36, v36
    v_mfma_f32_32x32x16_bf16 v[48:63], v[88:91], v[112:115], v[16:31]
    v_exp_f32 v37, v37
    v_exp_f32 v38, v38
    v_exp_f32 v39, v39
    v_mfma_f32_32x32x16_bf16 v[48:63], v[92:95], v[116:119], v[48:63]
    buffer_load_dwordx4 v245, s[88:91], s22 offen offset:2048 lds
    s_add_u32 s22, s22, s35
    v_exp_f32 v40, v40
    v_exp_f32 v41, v41
    v_exp_f32 v42, v42
    v_smfmac_f32_32x32x32_bf16 v[0:15], v[96:99], v[32:39], v128
    v_exp_f32 v43, v43
    v_exp_f32 v44, v44
    v_exp_f32 v45, v45
    v_smfmac_f32_16x16x64_bf16 v[120:123], v[124:127], v[32:39], v128
    v_exp_f32 v46, v46
    v_exp_f32 v47, v47
    v_exp_f32 v48, v48
    s_waitcnt lgkmcnt(0)
    v_smfmac_f32_32x32x32_bf16 v[0:15], v[100:103], v[40:47], v128
    ds_read_b128 v[88:91], v131 offset:20480
    v_exp_f32 v49, v49
    ds_read_b128 v[92:95], v131 offset:21504
    v_exp_f32 v50, v50
    ds_read_b128 v[96:99], v131 offset:18432
    v_exp_f32 v51, v51
    v_smfmac_f32_16x16x64_bf16 v[120:123], v[124:127], v[40:47], v128
    ds_read_b128 v[100:103], v131 offset:19456
    v_exp_f32 v52, v52
    v_mfma_f32_32x32x16_bf16 v[32:47], v[80:83], v[112:115], v[16:31]
    v_exp_f32 v53, v53
    v_exp_f32 v54, v54
    v_exp_f32 v55, v55
    v_mfma_f32_32x32x16_bf16 v[32:47], v[84:87], v[116:119], v[32:47]
    v_exp_f32 v56, v56
    v_exp_f32 v57, v57
    v_exp_f32 v58, v58
    v_smfmac_f32_32x32x32_bf16 v[0:15], v[104:107], v[48:55], v128
    v_exp_f32 v59, v59
    v_exp_f32 v60, v60
    v_exp_f32 v61, v61
    v_smfmac_f32_16x16x64_bf16 v[120:123], v[124:127], v[48:55], v128
    v_exp_f32 v62, v62
    v_exp_f32 v63, v63
    s_nop 1
    v_exp_f32 v32, v32
    s_waitcnt lgkmcnt(0)
    v_smfmac_f32_32x32x32_bf16 v[0:15], v[108:111], v[56:63], v128
    ds_read_b128 v[80:83], v131 offset:24576
    v_exp_f32 v33, v33
    ds_read_b128 v[84:87], v131 offset:25600
    v_exp_f32 v34, v34
    ds_read_b128 v[104:107], v131 offset:22528
    v_exp_f32 v35, v35
    v_smfmac_f32_16x16x64_bf16 v[120:123], v[124:127], v[56:63], v128
    ds_read_b128 v[108:111], v131 offset:23552
    v_exp_f32 v36, v36
    v_mfma_f32_32x32x16_bf16 v[48:63], v[88:91], v[112:115], v[16:31]
    v_exp_f32 v37, v37
    v_exp_f32 v38, v38
    v_exp_f32 v39, v39
    v_mfma_f32_32x32x16_bf16 v[48:63], v[92:95], v[116:119], v[48:63]
    buffer_load_dwordx4 v245, s[88:91], s22 offen offset:3072 lds
    s_add_u32 s22, s22, s35
    v_exp_f32 v40, v40
    v_exp_f32 v41, v41
    v_exp_f32 v42, v42
    v_smfmac_f32_32x32x32_bf16 v[0:15], v[96:99], v[32:39], v128
    v_exp_f32 v43, v43
    v_exp_f32 v44, v44
    v_exp_f32 v45, v45
    v_smfmac_f32_16x16x64_bf16 v[120:123], v[124:127], v[32:39], v128
    v_exp_f32 v46, v46
    v_exp_f32 v47, v47
    v_exp_f32 v48, v48
    s_waitcnt lgkmcnt(0)
    v_smfmac_f32_32x32x32_bf16 v[0:15], v[100:103], v[40:47], v128
    ds_read_b128 v[88:91], v131 offset:28672
    v_exp_f32 v49, v49
    ds_read_b128 v[92:95], v131 offset:29696
    v_exp_f32 v50, v50
    ds_read_b128 v[96:99], v131 offset:26624
    v_exp_f32 v51, v51
    v_smfmac_f32_16x16x64_bf16 v[120:123], v[124:127], v[40:47], v128
    ds_read_b128 v[100:103], v131 offset:27648
    v_exp_f32 v52, v52
    v_mfma_f32_32x32x16_bf16 v[32:47], v[80:83], v[112:115], v[16:31]
    v_exp_f32 v53, v53
    v_exp_f32 v54, v54
    v_exp_f32 v55, v55
    v_mfma_f32_32x32x16_bf16 v[32:47], v[84:87], v[116:119], v[32:47]
    v_exp_f32 v56, v56
    v_exp_f32 v57, v57
    v_exp_f32 v58, v58
    v_smfmac_f32_32x32x32_bf16 v[0:15], v[104:107], v[48:55], v128
    v_exp_f32 v59, v59
    v_exp_f32 v60, v60
    v_exp_f32 v61, v61
    v_smfmac_f32_16x16x64_bf16 v[120:123], v[124:127], v[48:55], v128
    v_exp_f32 v62, v62
    v_exp_f32 v63, v63
    s_nop 1
    v_exp_f32 v32, v32
    s_waitcnt lgkmcnt(0)
    v_smfmac_f32_32x32x32_bf16 v[0:15], v[108:111], v[56:63], v128
    s_waitcnt vmcnt(8)
    s_barrier
    ds_read_b128 v[80:83], v132 offset:0
    v_exp_f32 v33, v33
    ds_read_b128 v[84:87], v132 offset:1024
    v_exp_f32 v34, v34
    ds_read_b128 v[104:107], v131 offset:30720
    v_exp_f32 v35, v35
    v_smfmac_f32_16x16x64_bf16 v[120:123], v[124:127], v[56:63], v128
    ds_read_b128 v[108:111], v131 offset:31744
    v_exp_f32 v36, v36
    v_mfma_f32_32x32x16_bf16 v[48:63], v[88:91], v[112:115], v[16:31]
    v_exp_f32 v37, v37
    v_exp_f32 v38, v38
    v_exp_f32 v39, v39
    v_mfma_f32_32x32x16_bf16 v[48:63], v[92:95], v[116:119], v[48:63]
    s_add_u32 s21, s21, 0x8000
    s_sub_u32 s60, s21, 0x28000
    s_cselect_b32 s21, s21, s60
    s_mov_b32 m0, s21
    s_add_u32 s22, s22, s38
    s_and_b32 s22, s22, s39
    s_cmp_eq_u32 s33, 4
    s_cbranch_scc1 K2_SWITCH
K2_SWRET:
    buffer_load_dwordx4 v245, s[88:91], s22 offen offset:0 lds
    s_add_u32 s22, s22, s35
    v_exp_f32 v40, v40
    v_exp_f32 v41, v41
    v_exp_f32 v42, v42
    v_smfmac_f32_32x32x32_bf16 v[0:15], v[96:99], v[32:39], v128
    v_exp_f32 v43, v43
    v_exp_f32 v44, v44
    v_exp_f32 v45, v45
    v_smfmac_f32_16x16x64_bf16 v[120:123], v[124:127], v[32:39], v128
    v_exp_f32 v46, v46
    v_exp_f32 v47, v47
    v_exp_f32 v48, v48
    s_waitcnt lgkmcnt(0)
    v_smfmac_f32_32x32x32_bf16 v[0:15], v[100:103], v[40:47], v128
    ds_read_b128 v[88:91], v132 offset:4096
    v_exp_f32 v49, v49
    ds_read_b128 v[92:95], v132 offset:5120
    v_exp_f32 v50, v50
    ds_read_b128 v[96:99], v132 offset:2048
    v_exp_f32 v51, v51
    v_smfmac_f32_16x16x64_bf16 v[120:123], v[124:127], v[40:47], v128
    ds_read_b128 v[100:103], v132 offset:3072
    v_exp_f32 v52, v52
    v_mfma_f32_32x32x16_bf16 v[32:47], v[80:83], v[112:115], v[16:31]
    v_exp_f32 v53, v53
    v_exp_f32 v54, v54
    v_exp_f32 v55, v55
    v_mfma_f32_32x32x16_bf16 v[32:47], v[84:87], v[116:119], v[32:47]
    v_exp_f32 v56, v56
    v_exp_f32 v57, v57
    v_exp_f32 v58, v58
    v_smfmac_f32_32x32x32_bf16 v[0:15], v[104:107], v[48:55], v128
    v_exp_f32 v59, v59
    v_exp_f32 v60, v60
    v_exp_f32 v61, v61
    v_smfmac_f32_16x16x64_bf16 v[120:123], v[124:127], v[48:55], v128
    v_mov_b32 v131, v132
    s_add_u32 s32, s32, 0x8000
    s_cmp_eq_u32 s32, 0x28000
    s_cselect_b32 s32, 0, s32
    s_add_u32 s33, s33, 1
    s_cmp_lt_u32 s33, 8
    v_exp_f32 v62, v62
    v_add_u32 v132, s32, v130
    v_exp_f32 v63, v63
    s_cbranch_scc1 K2_LOOP
    s_nop 0
    v_smfmac_f32_32x32x32_bf16 v[0:15], v[108:111], v[56:63], v128
    v_smfmac_f32_16x16x64_bf16 v[120:123], v[124:127], v[56:63], v128
    s_mov_b64 exec, 1
    buffer_load_dword v224, v130, s[8:11], s49 offen offset:1024 sc1
    s_mov_b64 exec, -1
    v_mov_b64 v[134:135], 0
    s_mov_b32 s34, 0x6f800000
    s_nop 2
    v_mov_b32 v133, v120
    s_nop 1
    v_pk_fma_f32 v[134:135], v[0:1], 0, v[134:135]
    v_pk_fma_f32 v[134:135], v[2:3], 0, v[134:135]
    v_pk_fma_f32 v[134:135], v[4:5], 0, v[134:135]
    v_pk_fma_f32 v[134:135], v[6:7], 0, v[134:135]
    v_pk_fma_f32 v[134:135], v[8:9], 0, v[134:135]
    v_pk_fma_f32 v[134:135], v[10:11], 0, v[134:135]
    v_pk_fma_f32 v[134:135], v[12:13], 0, v[134:135]
    v_pk_fma_f32 v[134:135], v[14:15], 0, v[134:135]
    v_add_f32 v134, v134, v135
    v_add_f32 v134, v134, v133
    v_cmp_ngt_f32 vcc, s34, v134
    s_cbranch_vccnz K2_SLOW
K2_EPI:
    v_rcp_f32 v134, v133
    s_nop 0
    v_mov_b32 v135, v134
    v_pk_mul_f32 v[0:1], v[0:1], v[134:135]
    v_cvt_pk_bf16_f32 v32, v0, v1
    v_pk_mul_f32 v[2:3], v[2:3], v[134:135]
    v_cvt_pk_bf16_f32 v33, v2, v3
    v_pk_mul_f32 v[4:5], v[4:5], v[134:135]
    v_cvt_pk_bf16_f32 v34, v4, v5
    v_pk_mul_f32 v[6:7], v[6:7], v[134:135]
    v_cvt_pk_bf16_f32 v35, v6, v7
    buffer_store_dwordx4 v[32:35], v130, s[8:11], s24 offen sc1
    v_pk_mul_f32 v[8:9], v[8:9], v[134:135]
    v_cvt_pk_bf16_f32 v36, v8, v9
    v_pk_mul_f32 v[10:11], v[10:11], v[134:135]
    v_cvt_pk_bf16_f32 v37, v10, v11
    v_pk_mul_f32 v[12:13], v[12:13], v[134:135]
    v_cvt_pk_bf16_f32 v38, v12, v13
    v_pk_mul_f32 v[14:15], v[14:15], v[134:135]
    v_cvt_pk_bf16_f32 v39, v14, v15
    buffer_store_dwordx4 v[36:39], v130, s[8:11], s24 offen offset:1024 sc1
    s_waitcnt vmcnt(0)
    s_barrier
    v_readfirstlane_b32 s60, v224
    s_cmp_lt_u32 s60, 256
    s_cselect_b32 s46, 0, 1
    s_cmp_lg_u32 s3, 0
    s_cbranch_scc1 K2_YL
    v_readfirstlane_b32 s60, v244
    s_and_b32 s61, s2, 7
    s_lshl_b32 s61, s61, 3
    s_bfm_b64 s[42:43], 8, s61
    s_cmp_eq_u32 s60, 255
    s_cselect_b64 s[42:43], -1, s[42:43]
    s_cselect_b32 s44, 2, 0
    s_cselect_b32 s46, 1, s46
    s_cmp_eq_u32 s46, 0
    s_cbranch_scc1 K2_ABANDON
K2_PUB:
    s_lshl_b32 s60, s2, 2
    s_add_u32 s60, s60, 15859712
    v_mov_b32 v138, 2
    s_mov_b64 exec, 1
    buffer_store_dword v138, v130, s[8:11], s60 offen sc1
    s_mov_b64 exec, -1
K2_YL:
    buffer_load_dwordx4 v245, s[88:91], s22 offen offset:1024 lds
    s_add_u32 s22, s22, s35
    buffer_load_dwordx4 v245, s[88:91], s22 offen offset:2048 lds
    s_add_u32 s22, s22, s35
    buffer_load_dwordx4 v245, s[88:91], s22 offen offset:3072 lds
    s_add_u32 s22, s22, s35
    s_cmp_eq_u32 s46, 0
    s_cbranch_scc1 K2_NOY
    s_mov_b32 s59, 15794176
    buffer_load_dwordx2 v[140:141], v250, s[8:11], s59 offen
    s_mov_b32 s59, 20971520
    buffer_load_dword v64, v248, s[8:11], s59 offen sc1
    s_add_u32 s59, s59, s58
    buffer_load_dword v65, v248, s[8:11], s59 offen sc1
    s_add_u32 s59, s59, s58
    buffer_load_dword v66, v248, s[8:11], s59 offen sc1
    s_add_u32 s59, s59, s58
    buffer_load_dword v67, v248, s[8:11], s59 offen sc1
    s_add_u32 s59, s59, s58
    buffer_load_dword v68, v248, s[8:11], s59 offen sc1
    s_add_u32 s59, s59, s58
    buffer_load_dword v69, v248, s[8:11], s59 offen sc1
    s_add_u32 s59, s59, s58
    buffer_load_dword v70, v248, s[8:11], s59 offen sc1
    s_add_u32 s59, s59, s58
    buffer_load_dword v71, v248, s[8:11], s59 offen sc1
    s_add_u32 s59, s59, s58
    buffer_load_dword v72, v248, s[8:11], s59 offen sc1
    s_add_u32 s59, s59, s58
    buffer_load_dword v73, v248, s[8:11], s59 offen sc1
    s_add_u32 s59, s59, s58
    buffer_load_dword v74, v248, s[8:11], s59 offen sc1
    s_add_u32 s59, s59, s58
    buffer_load_dword v75, v248, s[8:11], s59 offen sc1
    s_add_u32 s59, s59, s58
    buffer_load_dword v76, v248, s[8:11], s59 offen sc1
    s_add_u32 s59, s59, s58
    buffer_load_dword v77, v248, s[8:11], s59 offen sc1
    s_add_u32 s59, s59, s58
    buffer_load_dword v78, v248, s[8:11], s59 offen sc1
    s_add_u32 s59, s59, s58
    buffer_load_dword v79, v248, s[8:11], s59 offen sc1
    s_cmp_lg_u32 s3, 0
    s_cbranch_scc1 K2_JOB
    s_mov_b64 exec, s[42:43]
K2_POLL:
    buffer_load_dwordx4 v[224:227], v130, s[8:11], s49 offen sc1
    s_waitcnt vmcnt(0)
    v_min3_u32 v133, v224, v225, v226
    v_min_u32 v133, v133, v227
    v_cmp_eq_u32 vcc, 0, v133
    s_cbranch_vccnz K2_POLL
K2_PEND:
    v_max3_u32 v133, v224, v225, v226
    v_max_u32 v133, v133, v227
    v_cmp_lt_u32 vcc, 2, v133
    s_mov_b64 exec, -1
    s_cmp_eq_u64 vcc, 0
    s_cselect_b32 s44, 0, s44
    v_mov_b32 v255, s44
K2_MODE:
    v_lshlrev_b32 v133, 12, v129
    v_add_u32 v133, 0x10000, v133
    s_mov_b64 exec, 0xff
    ds_write_b32 v133, v255
    s_mov_b64 exec, -1
    s_waitcnt lgkmcnt(0)
K2_JOB:
    s_waitcnt vmcnt(17)
    s_barrier
    buffer_load_dwordx4 v[32:35], v130, s[8:11], s54 offen offset:0 sc1
    buffer_load_dwordx4 v[36:39], v130, s[8:11], s54 offen offset:1024 sc1
    buffer_load_dwordx4 v[40:43], v130, s[8:11], s54 offen offset:2048 sc1
    buffer_load_dwordx4 v[44:47], v130, s[8:11], s54 offen offset:3072 sc1
    buffer_load_dwordx4 v[48:51], v252, s[8:11], s54 offen offset:0 sc1
    buffer_load_dwordx4 v[52:55], v252, s[8:11], s54 offen offset:1024 sc1
    v_add_u32 v253, s50, v247
    v_xor_b32 v254, 64, v253
    ds_read_b64_tr_b16 v[208:209], v253 offset:0
    ds_read_b64_tr_b16 v[210:211], v253 offset:1024
    ds_read_b64_tr_b16 v[212:213], v254 offset:0
    ds_read_b64_tr_b16 v[214:215], v254 offset:1024
    ds_read_b64_tr_b16 v[216:217], v253 offset:2048
    ds_read_b64_tr_b16 v[218:219], v253 offset:3072
    ds_read_b64_tr_b16 v[220:221], v254 offset:2048
    ds_read_b64_tr_b16 v[222:223], v254 offset:3072
    ds_read_b64_tr_b16 v[228:229], v253 offset:4096
    ds_read_b64_tr_b16 v[230:231], v253 offset:5120
    ds_read_b64_tr_b16 v[232:233], v254 offset:4096
    ds_read_b64_tr_b16 v[234:235], v254 offset:5120
    ds_read_b32 v255, v139
    s_waitcnt lgkmcnt(0)
    v_readfirstlane_b32 s47, v255
    s_cmp_eq_u32 s47, 1
    s_cbranch_scc1 K2_QUIT
    s_cmp_eq_u32 s46, 0
    s_cbranch_scc1 K2_YLATE
K2_GEMM:
    ds_read_b64_tr_b16 v[236:237], v253 offset:6144
    ds_read_b64_tr_b16 v[238:239], v253 offset:7168
    ds_read_b64_tr_b16 v[240:241], v254 offset:6144
    ds_read_b64_tr_b16 v[242:243], v254 offset:7168
    s_waitcnt vmcnt(5) lgkmcnt(12)
    v_mfma_f32_32x32x16_bf16 v[16:31], v[212:215], v[32:35], 0
    v_mfma_f32_32x32x16_bf16 v[0:15], v[208:211], v[32:35], 0
    buffer_load_dwordx4 v[56:59], v252, s[8:11], s54 offen offset:2048 sc1
    ds_read_b64_tr_b16 v[208:209], v253 offset:8192
    ds_read_b64_tr_b16 v[210:211], v253 offset:9216
    ds_read_b64_tr_b16 v[212:213], v254 offset:8192
    ds_read_b64_tr_b16 v[214:215], v254 offset:9216
    s_waitcnt vmcnt(5) lgkmcnt(12)
    v_mfma_f32_32x32x16_bf16 v[16:31], v[220:223], v[36:39], v[16:31]
    v_mfma_f32_32x32x16_bf16 v[0:15], v[216:219], v[36:39], v[0:15]
    buffer_load_dwordx4 v[60:63], v252, s[8:11], s54 offen offset:3072 sc1
    ds_read_b64_tr_b16 v[216:217], v253 offset:10240
    ds_read_b64_tr_b16 v[218:219], v253 offset:11264
    ds_read_b64_tr_b16 v[220:221], v254 offset:10240
    ds_read_b64_tr_b16 v[222:223], v254 offset:11264
    s_waitcnt vmcnt(5) lgkmcnt(12)
    v_mfma_f32_32x32x16_bf16 v[16:31], v[232:235], v[40:43], v[16:31]
    v_mfma_f32_32x32x16_bf16 v[0:15], v[228:231], v[40:43], v[0:15]
    buffer_load_dwordx4 v[80:83], v130, s[8:11], s55 offen offset:0 sc1
    v_mov_b32 v142, v141
    v_mov_b32 v143, v141
    v_mov_b32 v141, v140
    ds_read_b64_tr_b16 v[228:229], v253 offset:12288
    ds_read_b64_tr_b16 v[230:231], v253 offset:13312
    ds_read_b64_tr_b16 v[232:233], v254 offset:12288
    ds_read_b64_tr_b16 v[234:235], v254 offset:13312
    s_waitcnt vmcnt(5) lgkmcnt(12)
    v_mfma_f32_32x32x16_bf16 v[16:31], v[240:243], v[44:47], v[16:31]
    v_mfma_f32_32x32x16_bf16 v[0:15], v[236:239], v[44:47], v[0:15]
    buffer_load_dwordx4 v[84:87], v130, s[8:11], s55 offen offset:1024 sc1
    v_perm_b32 v64, v64, v64, v251
    v_perm_b32 v65, v65, v65, v251
    v_pk_mul_f32 v[64:65], v[64:65], v[140:141]
    ds_read_b64_tr_b16 v[236:237], v253 offset:14336
    ds_read_b64_tr_b16 v[238:239], v253 offset:15360
    ds_read_b64_tr_b16 v[240:241], v254 offset:14336
    ds_read_b64_tr_b16 v[242:243], v254 offset:15360
    s_waitcnt vmcnt(5) lgkmcnt(12)
    v_mfma_f32_32x32x16_bf16 v[16:31], v[212:215], v[48:51], v[16:31]
    v_mfma_f32_32x32x16_bf16 v[0:15], v[208:211], v[48:51], v[0:15]
    buffer_load_dwordx4 v[88:91], v130, s[8:11], s55 offen offset:2048 sc1
    v_perm_b32 v66, v66, v66, v251
    v_perm_b32 v67, v67, v67, v251
    v_pk_mul_f32 v[66:67], v[66:67], v[140:141]
    v_add_u32 v253, s51, v247
    v_xor_b32 v254, 64, v253
    ds_read_b64_tr_b16 v[208:209], v253 offset:0
    ds_read_b64_tr_b16 v[210:211], v253 offset:1024
    ds_read_b64_tr_b16 v[212:213], v254 offset:0
    ds_read_b64_tr_b16 v[214:215], v254 offset:1024
    s_waitcnt vmcnt(5) lgkmcnt(12)
    v_mfma_f32_32x32x16_bf16 v[16:31], v[220:223], v[52:55], v[16:31]
    v_mfma_f32_32x32x16_bf16 v[0:15], v[216:219], v[52:55], v[0:15]
    buffer_load_dwordx4 v[92:95], v130, s[8:11], s55 offen offset:3072 sc1
    v_perm_b32 v68, v68, v68, v251
    v_perm_b32 v69, v69, v69, v251
    v_pk_mul_f32 v[68:69], v[68:69], v[140:141]
    ds_read_b64_tr_b16 v[216:217], v253 offset:2048
    ds_read_b64_tr_b16 v[218:219], v253 offset:3072
    ds_read_b64_tr_b16 v[220:221], v254 offset:2048
    ds_read_b64_tr_b16 v[222:223], v254 offset:3072
    s_waitcnt vmcnt(5) lgkmcnt(12)
    v_mfma_f32_32x32x16_bf16 v[16:31], v[232:235], v[56:59], v[16:31]
    v_mfma_f32_32x32x16_bf16 v[0:15], v[228:231], v[56:59], v[0:15]
    buffer_load_dwordx4 v[96:99], v252, s[8:11], s55 offen offset:0 sc1
    v_perm_b32 v70, v70, v70, v251
    v_perm_b32 v71, v71, v71, v251
    v_pk_mul_f32 v[70:71], v[70:71], v[140:141]
    ds_read_b64_tr_b16 v[228:229], v253 offset:4096
    ds_read_b64_tr_b16 v[230:231], v253 offset:5120
    ds_read_b64_tr_b16 v[232:233], v254 offset:4096
    ds_read_b64_tr_b16 v[234:235], v254 offset:5120
    s_waitcnt vmcnt(5) lgkmcnt(12)
    v_mfma_f32_32x32x16_bf16 v[16:31], v[240:243], v[60:63], v[16:31]
    v_mfma_f32_32x32x16_bf16 v[0:15], v[236:239], v[60:63], v[0:15]
    buffer_load_dwordx4 v[100:103], v252, s[8:11], s55 offen offset:1024 sc1
    v_perm_b32 v72, v72, v72, v251
    v_perm_b32 v73, v73, v73, v251
    v_pk_mul_f32 v[72:73], v[72:73], v[140:141]
    ds_read_b64_tr_b16 v[236:237], v253 offset:6144
    ds_read_b64_tr_b16 v[238:239], v253 offset:7168
    ds_read_b64_tr_b16 v[240:241], v254 offset:6144
    ds_read_b64_tr_b16 v[242:243], v254 offset:7168
    s_waitcnt vmcnt(5) lgkmcnt(12)
    v_mfma_f32_32x32x16_bf16 v[16:31], v[212:215], v[80:83], v[16:31]
    v_mfma_f32_32x32x16_bf16 v[0:15], v[208:211], v[80:83], v[0:15]
    buffer_load_dwordx4 v[104:107], v252, s[8:11], s55 offen offset:2048 sc1
    v_perm_b32 v74, v74, v74, v251
    v_perm_b32 v75, v75, v75, v251
    v_pk_mul_f32 v[74:75], v[74:75], v[140:141]
    ds_read_b64_tr_b16 v[208:209], v253 offset:8192
    ds_read_b64_tr_b16 v[210:211], v253 offset:9216
    ds_read_b64_tr_b16 v[212:213], v254 offset:8192
    ds_read_b64_tr_b16 v[214:215], v254 offset:9216
    s_waitcnt vmcnt(5) lgkmcnt(12)
    v_mfma_f32_32x32x16_bf16 v[16:31], v[220:223], v[84:87], v[16:31]
    v_mfma_f32_32x32x16_bf16 v[0:15], v[216:219], v[84:87], v[0:15]
    buffer_load_dwordx4 v[108:111], v252, s[8:11], s55 offen offset:3072 sc1
    v_perm_b32 v76, v76, v76, v251
    v_perm_b32 v77, v77, v77, v251
    v_pk_mul_f32 v[76:77], v[76:77], v[140:141]
    ds_read_b64_tr_b16 v[216:217], v253 offset:10240
    ds_read_b64_tr_b16 v[218:219], v253 offset:11264
    ds_read_b64_tr_b16 v[220:221], v254 offset:10240
    ds_read_b64_tr_b16 v[222:223], v254 offset:11264
    s_waitcnt vmcnt(5) lgkmcnt(12)
    v_mfma_f32_32x32x16_bf16 v[16:31], v[232:235], v[88:91], v[16:31]
    v_mfma_f32_32x32x16_bf16 v[0:15], v[228:231], v[88:91], v[0:15]
    buffer_load_dwordx4 v[144:147], v130, s[8:11], s56 offen offset:0 sc1
    v_perm_b32 v78, v78, v78, v251
    v_perm_b32 v79, v79, v79, v251
    v_pk_mul_f32 v[78:79], v[78:79], v[140:141]
    ds_read_b64_tr_b16 v[228:229], v253 offset:12288
    ds_read_b64_tr_b16 v[230:231], v253 offset:13312
    ds_read_b64_tr_b16 v[232:233], v254 offset:12288
    ds_read_b64_tr_b16 v[234:235], v254 offset:13312
    s_waitcnt vmcnt(5) lgkmcnt(12)
    v_mfma_f32_32x32x16_bf16 v[16:31], v[240:243], v[92:95], v[16:31]
    v_mfma_f32_32x32x16_bf16 v[0:15], v[236:239], v[92:95], v[0:15]
    buffer_load_dwordx4 v[148:151], v130, s[8:11], s56 offen offset:1024 sc1
    ds_read_b64_tr_b16 v[236:237], v253 offset:14336
    ds_read_b64_tr_b16 v[238:239], v253 offset:15360
    ds_read_b64_tr_b16 v[240:241], v254 offset:14336
    ds_read_b64_tr_b16 v[242:243], v254 offset:15360
    s_waitcnt vmcnt(5) lgkmcnt(12)
    v_mfma_f32_32x32x16_bf16 v[16:31], v[212:215], v[96:99], v[16:31]
    v_mfma_f32_32x32x16_bf16 v[0:15], v[208:211], v[96:99], v[0:15]
    buffer_load_dwordx4 v[152:155], v130, s[8:11], s56 offen offset:2048 sc1
    v_add_u32 v253, s52, v247
    v_xor_b32 v254, 64, v253
    ds_read_b64_tr_b16 v[208:209], v253 offset:0
    ds_read_b64_tr_b16 v[210:211], v253 offset:1024
    ds_read_b64_tr_b16 v[212:213], v254 offset:0
    ds_read_b64_tr_b16 v[214:215], v254 offset:1024
    s_waitcnt vmcnt(5) lgkmcnt(12)
    v_mfma_f32_32x32x16_bf16 v[16:31], v[220:223], v[100:103], v[16:31]
    v_mfma_f32_32x32x16_bf16 v[0:15], v[216:219], v[100:103], v[0:15]
    buffer_load_dwordx4 v[156:159], v130, s[8:11], s56 offen offset:3072 sc1
    ds_read_b64_tr_b16 v[216:217], v253 offset:2048
    ds_read_b64_tr_b16 v[218:219], v253 offset:3072
    ds_read_b64_tr_b16 v[220:221], v254 offset:2048
    ds_read_b64_tr_b16 v[222:223], v254 offset:3072
    s_waitcnt vmcnt(5) lgkmcnt(12)
    v_mfma_f32_32x32x16_bf16 v[16:31], v[232:235], v[104:107], v[16:31]
    v_mfma_f32_32x32x16_bf16 v[0:15], v[228:231], v[104:107], v[0:15]
    buffer_load_dwordx4 v[160:163], v252, s[8:11], s56 offen offset:0 sc1
    ds_read_b64_tr_b16 v[228:229], v253 offset:4096
    ds_read_b64_tr_b16 v[230:231], v253 offset:5120
    ds_read_b64_tr_b16 v[232:233], v254 offset:4096
    ds_read_b64_tr_b16 v[234:235], v254 offset:5120
    s_waitcnt vmcnt(5) lgkmcnt(12)
    v_mfma_f32_32x32x16_bf16 v[16:31], v[240:243], v[108:111], v[16:31]
    v_mfma_f32_32x32x16_bf16 v[0:15], v[236:239], v[108:111], v[0:15]
    buffer_load_dwordx4 v[164:167], v252, s[8:11], s56 offen offset:1024 sc1
    ds_read_b64_tr_b16 v[236:237], v253 offset:6144
    ds_read_b64_tr_b16 v[238:239], v253 offset:7168
    ds_read_b64_tr_b16 v[240:241], v254 offset:6144
    ds_read_b64_tr_b16 v[242:243], v254 offset:7168
    s_waitcnt vmcnt(5) lgkmcnt(12)
    v_mfma_f32_32x32x16_bf16 v[16:31], v[212:215], v[144:147], v[16:31]
    v_mfma_f32_32x32x16_bf16 v[0:15], v[208:211], v[144:147], v[0:15]
    buffer_load_dwordx4 v[168:171], v252, s[8:11], s56 offen offset:2048 sc1
    ds_read_b64_tr_b16 v[208:209], v253 offset:8192
    ds_read_b64_tr_b16 v[210:211], v253 offset:9216
    ds_read_b64_tr_b16 v[212:213], v254 offset:8192
    ds_read_b64_tr_b16 v[214:215], v254 offset:9216
    s_waitcnt vmcnt(5) lgkmcnt(12)
    v_mfma_f32_32x32x16_bf16 v[16:31], v[220:223], v[148:151], v[16:31]
    v_mfma_f32_32x32x16_bf16 v[0:15], v[216:219], v[148:151], v[0:15]
    buffer_load_dwordx4 v[172:175], v252, s[8:11], s56 offen offset:3072 sc1
    ds_read_b64_tr_b16 v[216:217], v253 offset:10240
    ds_read_b64_tr_b16 v[218:219], v253 offset:11264
    ds_read_b64_tr_b16 v[220:221], v254 offset:10240
    ds_read_b64_tr_b16 v[222:223], v254 offset:11264
    s_waitcnt vmcnt(5) lgkmcnt(12)
    v_mfma_f32_32x32x16_bf16 v[16:31], v[232:235], v[152:155], v[16:31]
    v_mfma_f32_32x32x16_bf16 v[0:15], v[228:231], v[152:155], v[0:15]
    buffer_load_dwordx4 v[176:179], v130, s[8:11], s57 offen offset:0 sc1
    ds_read_b64_tr_b16 v[228:229], v253 offset:12288
    ds_read_b64_tr_b16 v[230:231], v253 offset:13312
    ds_read_b64_tr_b16 v[232:233], v254 offset:12288
    ds_read_b64_tr_b16 v[234:235], v254 offset:13312
    s_waitcnt vmcnt(5) lgkmcnt(12)
    v_mfma_f32_32x32x16_bf16 v[16:31], v[240:243], v[156:159], v[16:31]
    v_mfma_f32_32x32x16_bf16 v[0:15], v[236:239], v[156:159], v[0:15]
    buffer_load_dwordx4 v[180:183], v130, s[8:11], s57 offen offset:1024 sc1
    ds_read_b64_tr_b16 v[236:237], v253 offset:14336
    ds_read_b64_tr_b16 v[238:239], v253 offset:15360
    ds_read_b64_tr_b16 v[240:241], v254 offset:14336
    ds_read_b64_tr_b16 v[242:243], v254 offset:15360
    s_waitcnt vmcnt(5) lgkmcnt(12)
    v_mfma_f32_32x32x16_bf16 v[16:31], v[212:215], v[160:163], v[16:31]
    v_mfma_f32_32x32x16_bf16 v[0:15], v[208:211], v[160:163], v[0:15]
    buffer_load_dwordx4 v[184:187], v130, s[8:11], s57 offen offset:2048 sc1
    v_add_u32 v253, s53, v247
    v_xor_b32 v254, 64, v253
    ds_read_b64_tr_b16 v[208:209], v253 offset:0
    ds_read_b64_tr_b16 v[210:211], v253 offset:1024
    ds_read_b64_tr_b16 v[212:213], v254 offset:0
    ds_read_b64_tr_b16 v[214:215], v254 offset:1024
    s_waitcnt vmcnt(5) lgkmcnt(12)
    v_mfma_f32_32x32x16_bf16 v[16:31], v[220:223], v[164:167], v[16:31]
    v_mfma_f32_32x32x16_bf16 v[0:15], v[216:219], v[164:167], v[0:15]
    buffer_load_dwordx4 v[188:191], v130, s[8:11], s57 offen offset:3072 sc1
    ds_read_b64_tr_b16 v[216:217], v253 offset:2048
    ds_read_b64_tr_b16 v[218:219], v253 offset:3072
    ds_read_b64_tr_b16 v[220:221], v254 offset:2048
    ds_read_b64_tr_b16 v[222:223], v254 offset:3072
    s_waitcnt vmcnt(5) lgkmcnt(12)
    v_mfma_f32_32x32x16_bf16 v[16:31], v[232:235], v[168:171], v[16:31]
    v_mfma_f32_32x32x16_bf16 v[0:15], v[228:231], v[168:171], v[0:15]
    buffer_load_dwordx4 v[192:195], v252, s[8:11], s57 offen offset:0 sc1
    ds_read_b64_tr_b16 v[228:229], v253 offset:4096
    ds_read_b64_tr_b16 v[230:231], v253 offset:5120
    ds_read_b64_tr_b16 v[232:233], v254 offset:4096
    ds_read_b64_tr_b16 v[234:235], v254 offset:5120
    s_waitcnt vmcnt(5) lgkmcnt(12)
    v_mfma_f32_32x32x16_bf16 v[16:31], v[240:243], v[172:175], v[16:31]
    v_mfma_f32_32x32x16_bf16 v[0:15], v[236:239], v[172:175], v[0:15]
    buffer_load_dwordx4 v[196:199], v252, s[8:11], s57 offen offset:1024 sc1
    ds_read_b64_tr_b16 v[236:237], v253 offset:6144
    ds_read_b64_tr_b16 v[238:239], v253 offset:7168
    ds_read_b64_tr_b16 v[240:241], v254 offset:6144
    ds_read_b64_tr_b16 v[242:243], v254 offset:7168
    s_waitcnt vmcnt(5) lgkmcnt(12)
    v_mfma_f32_32x32x16_bf16 v[16:31], v[212:215], v[176:179], v[16:31]
    v_mfma_f32_32x32x16_bf16 v[0:15], v[208:211], v[176:179], v[0:15]
    buffer_load_dwordx4 v[200:203], v252, s[8:11], s57 offen offset:2048 sc1
    ds_read_b64_tr_b16 v[208:209], v253 offset:8192
    ds_read_b64_tr_b16 v[210:211], v253 offset:9216
    ds_read_b64_tr_b16 v[212:213], v254 offset:8192
    ds_read_b64_tr_b16 v[214:215], v254 offset:9216
    s_waitcnt vmcnt(5) lgkmcnt(12)
    v_mfma_f32_32x32x16_bf16 v[16:31], v[220:223], v[180:183], v[16:31]
    v_mfma_f32_32x32x16_bf16 v[0:15], v[216:219], v[180:183], v[0:15]
    buffer_load_dwordx4 v[204:207], v252, s[8:11], s57 offen offset:3072 sc1
    ds_read_b64_tr_b16 v[216:217], v253 offset:10240
    ds_read_b64_tr_b16 v[218:219], v253 offset:11264
    ds_read_b64_tr_b16 v[220:221], v254 offset:10240
    ds_read_b64_tr_b16 v[222:223], v254 offset:11264
    s_waitcnt vmcnt(5) lgkmcnt(12)
    v_mfma_f32_32x32x16_bf16 v[16:31], v[232:235], v[184:187], v[16:31]
    v_mfma_f32_32x32x16_bf16 v[0:15], v[228:231], v[184:187], v[0:15]
    ds_read_b64_tr_b16 v[228:229], v253 offset:12288
    ds_read_b64_tr_b16 v[230:231], v253 offset:13312
    ds_read_b64_tr_b16 v[232:233], v254 offset:12288
    ds_read_b64_tr_b16 v[234:235], v254 offset:13312
    s_waitcnt vmcnt(4) lgkmcnt(12)
    v_mfma_f32_32x32x16_bf16 v[16:31], v[240:243], v[188:191], v[16:31]
    v_mfma_f32_32x32x16_bf16 v[0:15], v[236:239], v[188:191], v[0:15]
    ds_read_b64_tr_b16 v[236:237], v253 offset:14336
    ds_read_b64_tr_b16 v[238:239], v253 offset:15360
    ds_read_b64_tr_b16 v[240:241], v254 offset:14336
    ds_read_b64_tr_b16 v[242:243], v254 offset:15360
    s_waitcnt vmcnt(3) lgkmcnt(12)
    v_mfma_f32_32x32x16_bf16 v[16:31], v[212:215], v[192:195], v[16:31]
    v_mfma_f32_32x32x16_bf16 v[0:15], v[208:211], v[192:195], v[0:15]
    s_waitcnt vmcnt(2) lgkmcnt(8)
    v_mfma_f32_32x32x16_bf16 v[16:31], v[220:223], v[196:199], v[16:31]
    v_mfma_f32_32x32x16_bf16 v[0:15], v[216:219], v[196:199], v[0:15]
    s_waitcnt vmcnt(1) lgkmcnt(4)
    v_mfma_f32_32x32x16_bf16 v[16:31], v[232:235], v[200:203], v[16:31]
    v_mfma_f32_32x32x16_bf16 v[0:15], v[228:231], v[200:203], v[0:15]
    s_waitcnt vmcnt(0) lgkmcnt(0)
    v_mfma_f32_32x32x16_bf16 v[16:31], v[240:243], v[204:207], v[16:31]
    v_mfma_f32_32x32x16_bf16 v[0:15], v[236:239], v[204:207], v[0:15]
    v_xor_b32 v134, 0x4000, v139
    s_nop 9
    ds_write_b128 v139, v[16:19] offset:0
    ds_write_b128 v139, v[20:23] offset:1024
    ds_write_b128 v139, v[24:27] offset:2048
    ds_write_b128 v139, v[28:31] offset:3072
    v_pk_fma_f32 v[64:65], v[0:1], v[142:143], v[64:65]
    v_pk_fma_f32 v[66:67], v[2:3], v[142:143], v[66:67]
    v_pk_fma_f32 v[68:69], v[4:5], v[142:143], v[68:69]
    v_pk_fma_f32 v[70:71], v[6:7], v[142:143], v[70:71]
    v_pk_fma_f32 v[72:73], v[8:9], v[142:143], v[72:73]
    v_pk_fma_f32 v[74:75], v[10:11], v[142:143], v[74:75]
    v_pk_fma_f32 v[76:77], v[12:13], v[142:143], v[76:77]
    v_pk_fma_f32 v[78:79], v[14:15], v[142:143], v[78:79]
    s_waitcnt lgkmcnt(0)
    s_barrier
    ds_read_b128 v[16:19], v134 offset:0
    ds_read_b128 v[20:23], v134 offset:1024
    ds_read_b128 v[24:27], v134 offset:2048
    ds_read_b128 v[28:31], v134 offset:3072
    s_waitcnt lgkmcnt(3)
    v_pk_fma_f32 v[64:65], v[16:17], v[142:143], v[64:65]
    v_cvt_pk_bf16_f32 v0, v64, v65
    v_pk_fma_f32 v[66:67], v[18:19], v[142:143], v[66:67]
    v_cvt_pk_bf16_f32 v1, v66, v67
    s_waitcnt lgkmcnt(2)
    v_pk_fma_f32 v[68:69], v[20:21], v[142:143], v[68:69]
    v_cvt_pk_bf16_f32 v2, v68, v69
    v_pk_fma_f32 v[70:71], v[22:23], v[142:143], v[70:71]
    v_cvt_pk_bf16_f32 v3, v70, v71
    buffer_store_dwordx4 v[0:3], v249, s[16:19], 0 offen offset:0
    s_waitcnt lgkmcnt(1)
    v_pk_fma_f32 v[72:73], v[24:25], v[142:143], v[72:73]
    v_cvt_pk_bf16_f32 v4, v72, v73
    v_pk_fma_f32 v[74:75], v[26:27], v[142:143], v[74:75]
    v_cvt_pk_bf16_f32 v5, v74, v75
    s_waitcnt lgkmcnt(0)
    v_pk_fma_f32 v[76:77], v[28:29], v[142:143], v[76:77]
    v_cvt_pk_bf16_f32 v6, v76, v77
    v_pk_fma_f32 v[78:79], v[30:31], v[142:143], v[78:79]
    v_cvt_pk_bf16_f32 v7, v78, v79
    buffer_store_dwordx4 v[4:7], v249, s[16:19], 0 offen offset:16
    s_cmp_eq_u32 s47, 2
    s_cbranch_scc1 K2_HELP
K2_FIN:
K2_END:
    s_endpgm
K2_SWITCH:
    s_mov_b64 s[88:89], s[12:13]
    s_mov_b64 s[90:91], s[14:15]
    s_mov_b32 s22, s40
    s_movk_i32 s35, 15360
    s_mov_b32 s38, 462848
    s_mov_b32 s39, 0x1fffff
    v_mov_b32 v245, v246
    s_cmp_lg_u32 s3, 0
    s_cbranch_scc1 K2_SWRET
    v_mov_b32 v244, 1
    s_mov_b64 exec, 1
    buffer_atomic_add v244, v130, s[8:11], s49 offen offset:1024 sc0 sc1
    s_mov_b64 exec, -1
    s_branch K2_SWRET
K2_NOY:
    s_waitcnt vmcnt(0)
    s_branch K2_JOB
K2_ABANDON:
    s_lshl_b32 s60, s2, 2
    s_add_u32 s60, s60, 15859712
    v_mov_b32 v138, 3
    s_mov_b64 exec, 1
    buffer_store_dword v138, v130, s[8:11], s60 offen sc1
    s_mov_b64 exec, -1
    v_mov_b32 v255, 1
    s_branch K2_MODE
K2_QUIT:
    s_waitcnt vmcnt(0)
    s_endpgm
K2_YLATE:
    s_mov_b32 s59, 15794176
    buffer_load_dwordx2 v[140:141], v250, s[8:11], s59 offen
    s_mov_b32 s59, 20971520
    buffer_load_dword v64, v248, s[8:11], s59 offen sc1
    s_add_u32 s59, s59, s58
    buffer_load_dword v65, v248, s[8:11], s59 offen sc1
    s_add_u32 s59, s59, s58
    buffer_load_dword v66, v248, s[8:11], s59 offen sc1
    s_add_u32 s59, s59, s58
    buffer_load_dword v67, v248, s[8:11], s59 offen sc1
    s_add_u32 s59, s59, s58
    buffer_load_dword v68, v248, s[8:11], s59 offen sc1
    s_add_u32 s59, s59, s58
    buffer_load_dword v69, v248, s[8:11], s59 offen sc1
    s_add_u32 s59, s59, s58
    buffer_load_dword v70, v248, s[8:11], s59 offen sc1
    s_add_u32 s59, s59, s58
    buffer_load_dword v71, v248, s[8:11], s59 offen sc1
    s_add_u32 s59, s59, s58
    buffer_load_dword v72, v248, s[8:11], s59 offen sc1
    s_add_u32 s59, s59, s58
    buffer_load_dword v73, v248, s[8:11], s59 offen sc1
    s_add_u32 s59, s59, s58
    buffer_load_dword v74, v248, s[8:11], s59 offen sc1
    s_add_u32 s59, s59, s58
    buffer_load_dword v75, v248, s[8:11], s59 offen sc1
    s_add_u32 s59, s59, s58
    buffer_load_dword v76, v248, s[8:11], s59 offen sc1
    s_add_u32 s59, s59, s58
    buffer_load_dword v77, v248, s[8:11], s59 offen sc1
    s_add_u32 s59, s59, s58
    buffer_load_dword v78, v248, s[8:11], s59 offen sc1
    s_add_u32 s59, s59, s58
    buffer_load_dword v79, v248, s[8:11], s59 offen sc1
    s_waitcnt vmcnt(0)
    s_branch K2_GEMM
K2_HELP:
    s_cmp_eq_u32 s48, s2
    s_cselect_b32 s48, -1, s48
K2_HNEXT:
    s_add_u32 s48, s48, 1
    s_cmp_ge_u32 s48, 256
    s_cbranch_scc1 K2_FIN
    s_lshl_b32 s60, s48, 2
    s_add_u32 s60, s60, 15859712
    buffer_load_dword v224, v130, s[8:11], s60 offen sc1
    s_waitcnt vmcnt(0)
    v_readfirstlane_b32 s60, v224
    s_cmp_eq_u32 s60, 3
    s_cbranch_scc0 K2_HNEXT
    s_barrier
    s_and_b32 s41, s48, 7
    s_lshl_b32 s41, s41, 1
    s_bfe_u32 s42, s48, 0x10003
    s_add_u32 s41, s41, s42
    s_lshr_b32 s42, s48, 4
    s_and_b32 s43, s3, 3
    s_lshr_b32 s44, s3, 2
    s_lshl_b32 s41, s41, 2
    s_add_u32 s41, s41, s43
    s_lshl_b32 s40, s3, 16
    s_lshl_b32 s43, s42, 7
    s_add_u32 s40, s40, s43
    s_and_b32 s36, s48, 3
    s_lshl_b32 s43, s36, 19
    s_add_u32 s40, s40, s43
    s_lshl_b32 s36, s36, 1
    s_lshl_b32 s60, s41, 16
    s_lshl_b32 s61, s44, 15
    s_add_u32 s60, s60, s61
    s_add_u32 s60, s60, 16777216
    s_add_u32 s43, s42, 0
    s_and_b32 s43, s43, 3
    s_lshl_b32 s61, s43, 13
    s_add_u32 s54, s60, s61
    s_lshl_b32 s61, s44, 2
    s_add_u32 s43, s43, s61
    s_sub_u32 s43, s43, s36
    s_and_b32 s43, s43, 7
    s_cmp_ge_u32 s43, 4
    s_cselect_b32 s61, -4, 6
    s_add_u32 s43, s43, s61
    s_lshl_b32 s50, s43, 14
    s_add_u32 s43, s42, 1
    s_and_b32 s43, s43, 3
    s_lshl_b32 s61, s43, 13
    s_add_u32 s55, s60, s61
    s_lshl_b32 s61, s44, 2
    s_add_u32 s43, s43, s61
    s_sub_u32 s43, s43, s36
    s_and_b32 s43, s43, 7
    s_cmp_ge_u32 s43, 4
    s_cselect_b32 s61, -4, 6
    s_add_u32 s43, s43, s61
    s_lshl_b32 s51, s43, 14
    s_add_u32 s43, s42, 2
    s_and_b32 s43, s43, 3
    s_lshl_b32 s61, s43, 13
    s_add_u32 s56, s60, s61
    s_lshl_b32 s61, s44, 2
    s_add_u32 s43, s43, s61
    s_sub_u32 s43, s43, s36
    s_and_b32 s43, s43, 7
    s_cmp_ge_u32 s43, 4
    s_cselect_b32 s61, -4, 6
    s_add_u32 s43, s43, s61
    s_lshl_b32 s52, s43, 14
    s_add_u32 s43, s42, 3
    s_and_b32 s43, s43, 3
    s_lshl_b32 s61, s43, 13
    s_add_u32 s57, s60, s61
    s_lshl_b32 s61, s44, 2
    s_add_u32 s43, s43, s61
    s_sub_u32 s43, s43, s36
    s_and_b32 s43, s43, 7
    s_cmp_ge_u32 s43, 4
    s_cselect_b32 s61, -4, 6
    s_add_u32 s43, s43, s61
    s_lshl_b32 s53, s43, 14
    v_lshrrev_b32 v133, 3, v129
    v_and_b32 v134, 7, v129
    v_bfe_u32 v135, v129, 4, 1
    v_lshlrev_b32 v135, 2, v135
    v_xor_b32 v134, v134, v135
    v_lshlrev_b32 v134, 4, v134
    v_lshl_or_b32 v246, v133, 11, v134
    v_lshrrev_b32 v133, 5, v129
    v_bfe_u32 v134, v129, 2, 2
    v_lshl_or_b32 v134, v133, 2, v134
    v_lshlrev_b32 v247, 7, v134
    v_bfe_u32 v134, v129, 3, 1
    v_xor_b32 v134, s44, v134
    v_lshl_or_b32 v247, v134, 6, v247
    v_and_b32 v134, 1, v129
    v_lshl_or_b32 v247, v134, 5, v247
    v_mul_u32_u24 v251, 0x202, v134
    v_lshlrev_b32 v251, 16, v251
    v_add_u32 v251, 0x01000c0c, v251
    v_bfe_u32 v134, v129, 4, 1
    v_lshl_or_b32 v247, v134, 4, v247
    v_bfe_u32 v134, v129, 1, 1
    v_lshl_or_b32 v247, v134, 3, v247
    v_add_u32 v252, 4096, v130
    s_lshl_b32 s61, s3, 12
    s_add_u32 s61, s61, 0x10000
    v_add_u32 v139, s61, v130
    v_and_b32 v134, 31, v129
    s_lshl_b32 s61, s41, 5
    v_add_u32 v134, s61, v134
    s_lshl_b32 s60, s42, 6
    s_lshl_b32 s61, s44, 5
    s_add_u32 s60, s60, s61
    v_lshlrev_b32 v135, 4, v133
    v_add_u32 v135, s60, v135
    v_lshlrev_b32 v249, 11, v134
    v_lshl_or_b32 v249, v135, 1, v249
    v_lshlrev_b32 v250, 3, v134
    v_sub_u32 v136, 2048, v134
    v_sub_u32 v137, 1024, v135
    s_cmp_lt_u32 s42, 8
    s_cselect_b64 vcc, 0, -1
    s_movk_i32 s58, -4224
    s_cselect_b32 s58, 4224, s58
    v_cndmask_b32 v134, v134, v136, vcc
    v_cndmask_b32 v135, v135, v137, vcc
    v_mul_u32_u24 v248, 4224, v135
    v_and_b32 v134, -2, v134
    v_lshl_add_u32 v248, v134, 1, v248
    s_lshl_b32 s59, s3, 12
    s_add_u32 m0, s59, 98304
    s_nop 0
    buffer_load_dwordx4 v246, s[12:15], s40 offen offset:0 lds
    s_add_u32 s40, s40, 15360
    buffer_load_dwordx4 v246, s[12:15], s40 offen offset:1024 lds
    s_add_u32 s40, s40, 15360
    buffer_load_dwordx4 v246, s[12:15], s40 offen offset:2048 lds
    s_add_u32 s40, s40, 15360
    buffer_load_dwordx4 v246, s[12:15], s40 offen offset:3072 lds
    s_add_u32 s40, s40, 478208
    s_and_b32 s40, s40, 0x1fffff
    s_add_u32 m0, s59, 131072
    s_nop 0
    buffer_load_dwordx4 v246, s[12:15], s40 offen offset:0 lds
    s_add_u32 s40, s40, 15360
    buffer_load_dwordx4 v246, s[12:15], s40 offen offset:1024 lds
    s_add_u32 s40, s40, 15360
    buffer_load_dwordx4 v246, s[12:15], s40 offen offset:2048 lds
    s_add_u32 s40, s40, 15360
    buffer_load_dwordx4 v246, s[12:15], s40 offen offset:3072 lds
    s_add_u32 s40, s40, 478208
    s_and_b32 s40, s40, 0x1fffff
    s_add_u32 m0, s59, 0
    s_nop 0
    buffer_load_dwordx4 v246, s[12:15], s40 offen offset:0 lds
    s_add_u32 s40, s40, 15360
    buffer_load_dwordx4 v246, s[12:15], s40 offen offset:1024 lds
    s_add_u32 s40, s40, 15360
    buffer_load_dwordx4 v246, s[12:15], s40 offen offset:2048 lds
    s_add_u32 s40, s40, 15360
    buffer_load_dwordx4 v246, s[12:15], s40 offen offset:3072 lds
    s_add_u32 s40, s40, 478208
    s_and_b32 s40, s40, 0x1fffff
    s_add_u32 m0, s59, 32768
    s_nop 0
    buffer_load_dwordx4 v246, s[12:15], s40 offen offset:0 lds
    s_add_u32 s40, s40, 15360
    buffer_load_dwordx4 v246, s[12:15], s40 offen offset:1024 lds
    s_add_u32 s40, s40, 15360
    buffer_load_dwordx4 v246, s[12:15], s40 offen offset:2048 lds
    s_add_u32 s40, s40, 15360
    buffer_load_dwordx4 v246, s[12:15], s40 offen offset:3072 lds
    s_add_u32 s40, s40, 478208
    s_and_b32 s40, s40, 0x1fffff
    s_mov_b32 s46, 0
    v_mov_b32 v255, 2
    ds_write_b32 v139, v255
    s_waitcnt vmcnt(0) lgkmcnt(0)
    s_barrier
    s_branch K2_JOB
K2_SLOW:
    s_waitcnt lgkmcnt(0)
    v_mov_b32 v133, 0xff800000
    s_mov_b32 s45, s20
    s_mov_b32 s33, 0
K2_SL1:
    buffer_load_dwordx4 v[80:83], v130, s[8:11], s45 offen offset:0
    buffer_load_dwordx4 v[84:87], v130, s[8:11], s45 offen offset:1024
    s_add_u32 s45, s45, 4096
    s_waitcnt vmcnt(0)
    v_mfma_f32_32x32x16_bf16 v[32:47], v[80:83], v[112:115], 0
    v_mfma_f32_32x32x16_bf16 v[32:47], v[84:87], v[116:119], v[32:47]
    s_nop 11
    v_max3_f32 v133, v32, v33, v133
    v_max3_f32 v133, v34, v35, v133
    v_max3_f32 v133, v36, v37, v133
    v_max3_f32 v133, v38, v39, v133
    v_max3_f32 v133, v40, v41, v133
    v_max3_f32 v133, v42, v43, v133
    v_max3_f32 v133, v44, v45, v133
    v_max3_f32 v133, v46, v47, v133
    s_add_u32 s33, s33, 1
    s_cmp_lt_u32 s33, 64
    s_cbranch_scc1 K2_SL1
    v_mov_b32 v134, v133
    s_nop 1
    v_permlane32_swap_b32 v133, v134
    v_max_f32 v133, v133, v134
    v_sub_f32 v16, 0, v133
    v_sub_f32 v17, 0, v133
    v_mov_b64 v[18:19], v[16:17]
    v_mov_b64 v[20:21], v[16:17]
    v_mov_b64 v[22:23], v[16:17]
    v_mov_b64 v[24:25], v[16:17]
    v_mov_b64 v[26:27], v[16:17]
    v_mov_b64 v[28:29], v[16:17]
    v_mov_b64 v[30:31], v[16:17]
    v_mov_b64 v[0:1], 0
    v_mov_b64 v[2:3], 0
    v_mov_b64 v[4:5], 0
    v_mov_b64 v[6:7], 0
    v_mov_b64 v[8:9], 0
    v_mov_b64 v[10:11], 0
    v_mov_b64 v[12:13], 0
    v_mov_b64 v[14:15], 0
    v_mov_b64 v[120:121], 0
    v_mov_b64 v[122:123], 0
    s_mov_b32 s45, s20
    s_mov_b32 s33, 0
K2_SL2:
    buffer_load_dwordx4 v[80:83], v130, s[8:11], s45 offen offset:0
    buffer_load_dwordx4 v[84:87], v130, s[8:11], s45 offen offset:1024
    buffer_load_dwordx4 v[96:99], v130, s[8:11], s45 offen offset:2048
    buffer_load_dwordx4 v[100:103], v130, s[8:11], s45 offen offset:3072
    s_add_u32 s45, s45, 4096
    s_waitcnt vmcnt(0)
    v_mfma_f32_32x32x16_bf16 v[32:47], v[80:83], v[112:115], v[16:31]
    v_mfma_f32_32x32x16_bf16 v[32:47], v[84:87], v[116:119], v[32:47]
    s_nop 11
    v_exp_f32 v32, v32
    v_exp_f32 v33, v33
    v_exp_f32 v34, v34
    v_exp_f32 v35, v35
    v_exp_f32 v36, v36
    v_exp_f32 v37, v37
    v_exp_f32 v38, v38
    v_exp_f32 v39, v39
    v_exp_f32 v40, v40
    v_exp_f32 v41, v41
    v_exp_f32 v42, v42
    v_exp_f32 v43, v43
    v_exp_f32 v44, v44
    v_exp_f32 v45, v45
    v_exp_f32 v46, v46
    v_exp_f32 v47, v47
    v_smfmac_f32_32x32x32_bf16 v[0:15], v[96:99], v[32:39], v128
    s_nop 0
    v_smfmac_f32_32x32x32_bf16 v[0:15], v[100:103], v[40:47], v128
    v_smfmac_f32_16x16x64_bf16 v[120:123], v[124:127], v[32:39], v128
    v_smfmac_f32_16x16x64_bf16 v[120:123], v[124:127], v[40:47], v128
    s_add_u32 s33, s33, 1
    s_cmp_lt_u32 s33, 64
    s_cbranch_scc1 K2_SL2
    s_nop 7
    s_nop 7
    v_mov_b32 v133, v120
    s_branch K2_EPI
TEXT_END:
.section .rodata,"a"
.p2align 6
.amdhsa_kernel k1_kernel
  .amdhsa_next_free_vgpr 256
  .amdhsa_next_free_sgpr 96
  .amdhsa_accum_offset 256
  .amdhsa_group_segment_fixed_size 0
  .amdhsa_kernarg_size 96
  .amdhsa_user_sgpr_count 2
  .amdhsa_user_sgpr_kernarg_segment_ptr 1
  .amdhsa_system_sgpr_workgroup_id_x 1
.end_amdhsa_kernel
.p2align 6
.amdhsa_kernel k2_kernel
  .amdhsa_next_free_vgpr 256
  .amdhsa_next_free_sgpr 96
  .amdhsa_accum_offset 256
  .amdhsa_group_segment_fixed_size 0
  .amdhsa_kernarg_size 96
  .amdhsa_user_sgpr_count 2
  .amdhsa_user_sgpr_kernarg_segment_ptr 1
  .amdhsa_system_sgpr_workgroup_id_x 1
.end_amdhsa_kernel
```
